```python
import torch

def _softmax(x, axis=-1):
    return torch.softmax(x, dim=axis)
def _gelu(x):
    return torch.nn.functional.gelu(x, approximate="tanh")
def _silu(x):
    return torch.nn.functional.silu(x)
def _sigmoid(x):
    return torch.sigmoid(x)
def _layernorm(x, axis=-1, eps=1e-5):
    m = x.mean(dim=axis, keepdim=True)
    v = x.var(dim=axis, keepdim=True, unbiased=False)
    return (x - m) / torch.sqrt(v + eps)
def _scatter_add(tgt, idx, src, axis=0):
    return tgt.clone().index_add_(axis, idx, src)
def _segment_sum(src, seg, n):
    out = torch.zeros((n,) + src.shape[1:], dtype=src.dtype)
    return out.index_add_(0, seg, src)
def _pad(x, pw):
    flat = tuple(v for pair in reversed(pw) for v in pair)
    return torch.nn.functional.pad(x, flat)

kernel_name = 'sequential_preLN__ssm_conv_h3__glu_gated_geglu__prompt'

def setup_inputs():

    _w = (lambda a: (lambda t: t.to(torch.bfloat16) if t.is_floating_point() else t)(torch.as_tensor(a)))
    def _A_setup():
        B, S, D = 1, 2048, 640
        ks = 4
        return {
            "q": _w((lambda *s: torch.randn(*s, dtype=torch.bfloat16) * 0.05)(B, S, D)),
            "k": _w((lambda *s: torch.randn(*s, dtype=torch.bfloat16) * 0.2)(B, S, D)),
            "v": _w((lambda *s: torch.randn(*s, dtype=torch.bfloat16) * 0.2)(B, S, D)),
            "shift_k": _w((lambda *s: torch.randn(*s, dtype=torch.bfloat16) * 0.2)(D, ks) * 0.5),
            "ssm_k": _w((lambda *s: torch.randn(*s, dtype=torch.bfloat16) * 0.4)(D, S) * (1.0 / S ** 0.5)),
            "ssm_D": _w((lambda *s: torch.randn(*s, dtype=torch.bfloat16) * 0.2)(D)),
        }
    _A_in = _A_setup()

    def _B_setup():
        B, S, Dm, Df = 1, 2048, 640, 1536
        return {
            "x": _w((lambda *s: torch.randn(*s, dtype=torch.bfloat16) * 0.05)(B, S, Dm)),
            "w_gate": _w((lambda *s: torch.randn(*s, dtype=torch.bfloat16) * 0.4)(Dm, Df) * (Dm ** -0.5)),
            "w_up": _w((lambda *s: torch.randn(*s, dtype=torch.bfloat16) * 0.4)(Dm, Df) * (Dm ** -0.5)),
            "w_down": _w((lambda *s: torch.randn(*s, dtype=torch.bfloat16) * 0.4)(Df, Dm) * (Df ** -0.5)),
        }
    _B_in = _B_setup()

    return {
        "A_q": _A_in["q"],
        "A_k": _A_in["k"],
        "A_v": _A_in["v"],
        "A_shift_k": _A_in["shift_k"],
        "A_ssm_k": _A_in["ssm_k"],
        "A_ssm_D": _A_in["ssm_D"],
        "B_x": _B_in["x"],
        "B_w_gate": _B_in["w_gate"],
        "B_w_up": _B_in["w_up"],
        "B_w_down": _B_in["w_down"],
    }

def reference(A_q, A_k, A_v, A_shift_k, A_ssm_k, A_ssm_D, B_x, B_w_gate, B_w_up, B_w_down):
    def _A_ref(q, k, v, shift_k, ssm_k, ssm_D):
        B, S, D = q.shape
        ks = shift_k.shape[-1]
        k_pad = _pad(k, ((0, 0), (ks - 1, 0), (0, 0)))
        k_shift = torch.zeros_like(k)
        for t in range(ks):
            k_shift = k_shift + k_pad[:, t:t + S, :] * shift_k[:, ks - 1 - t][None, None, :]
        kv = k_shift * v
        L = 2 * S
        kv_pad = _pad(kv, ((0, 0), (0, S), (0, 0)))
        kf_pad = _pad(ssm_k, ((0, 0), (0, S)))
        kv_f = (lambda x, axes=(-2,-1): torch.fft.rfft2(x.float(), dim=axes))(kv_pad[:, None, :, :], axes=(1, 2))
        kf_f = (lambda x, axes=(-2,-1): torch.fft.rfft2(x.float(), dim=axes))(kf_pad[:, None, :], axes=(1, 2))
        kf_f = (lambda x, *d: x.permute(*d))(kf_f, 1, 2, 0)
        y_f = kv_f * kf_f[None, :, :, :]
        y = (lambda x, s, axes=(-2,-1): torch.fft.irfft2(x, s=s, dim=axes).to(torch.bfloat16))(y_f, (1, L), axes=(1, 2))[:, 0, :S, :]
        y = y + kv * ssm_D[None, None, :]
        return q * y

    def _B_ref(x, w_gate, w_up, w_down):
        g = torch.einsum("bsd,df->bsf", x, w_gate)
        u = torch.einsum("bsd,df->bsf", x, w_up)
        h = _gelu(g) * u
        return torch.einsum("bsf,fd->bsd", h, w_down)

    x = A_q
    h = x + _A_ref(_layernorm(x, axis=-1), A_k, A_v, A_shift_k, A_ssm_k, A_ssm_D)
    h2 = h + _B_ref(_layernorm(h, axis=-1), B_w_gate, B_w_up, B_w_down)
    return h2
```

```asm
; @launch kernel=k0_kernel grid=(408,1,1) block=(256,1,1) lds=33792
; @launch kernel=k1_kernel grid=(748,1,1) block=(256,1,1) lds=38144
; @launch kernel=k2_kernel grid=(256,1,1) block=(512,1,1) lds=145408
; @launch kernel=k3_kernel grid=(256,1,1) block=(512,1,1) lds=155648
.amdgcn_target "amdgcn-amd-amdhsa--gfx950"
.text
.p2align 8
.globl k0_kernel
.type k0_kernel,@function
k0_kernel:
    s_cmp_ge_u32 s2, 408
    s_cbranch_scc1 L_k0_end
    s_load_dwordx4 s[4:7], s[0:1], 0
    s_load_dwordx4 s[8:11], s[0:1], 16
    s_load_dwordx2 s[12:13], s[0:1], 96
    s_load_dwordx4 s[48:51], s[0:1], 56
    s_cmp_ge_u32 s2, 160
    s_cbranch_scc1 L_k0_o
    s_and_b32 s14, s2, 31
    s_lshr_b32 s15, s2, 5
    v_lshrrev_b32 v1, 5, v0
    v_and_b32 v2, 31, v0
    s_lshl_b32 s16, s14, 6
    v_lshl_add_u32 v3, v1, 3, s16
    s_lshl_b32 s17, s15, 7
    v_lshl_add_u32 v4, v2, 2, s17
    v_mul_u32_u24 v5, 1280, v3
    v_lshl_add_u32 v5, v4, 1, v5
    v_subrev_u32 v6, 3840, v5
    v_lshlrev_b32 v7, 3, v4
    s_movk_i32 s40, 3840
    s_movk_i32 s41, 7680
    s_mov_b32 s19, 0
    s_waitcnt lgkmcnt(0)
    s_mov_b32 s20, s4
    s_mov_b32 s21, s5
    s_mov_b32 s22, 2621440
    s_mov_b32 s23, 0x00020000
    s_mov_b32 s24, s6
    s_mov_b32 s25, s7
    s_mov_b32 s26, 2621440
    s_mov_b32 s27, 0x00020000
    s_mov_b32 s28, s8
    s_mov_b32 s29, s9
    s_mov_b32 s30, 2621440
    s_mov_b32 s31, 0x00020000
    s_mov_b32 s32, s10
    s_mov_b32 s33, s11
    s_mov_b32 s34, 5120
    s_mov_b32 s35, 0x00020000
    s_mov_b32 s36, s12
    s_mov_b32 s37, s13
    s_mov_b32 s38, 8388608
    s_mov_b32 s39, 0x00020000
    buffer_load_dwordx4 v[8:11], v7, s[32:35], 0 offen
    buffer_load_dwordx4 v[12:15], v7, s[32:35], 0 offen offset:16
    buffer_load_dwordx2 v[16:17], v6, s[24:27], 0 offen offset:0
    buffer_load_dwordx2 v[18:19], v6, s[24:27], 0 offen offset:1280
    buffer_load_dwordx2 v[20:21], v6, s[24:27], 0 offen offset:2560
    buffer_load_dwordx2 v[22:23], v5, s[24:27], 0 offen offset:0
    buffer_load_dwordx2 v[24:25], v5, s[24:27], 0 offen offset:1280
    buffer_load_dwordx2 v[26:27], v5, s[24:27], 0 offen offset:2560
    buffer_load_dwordx2 v[28:29], v5, s[24:27], s40 offen offset:0
    buffer_load_dwordx2 v[30:31], v5, s[24:27], s40 offen offset:1280
    buffer_load_dwordx2 v[32:33], v5, s[24:27], s40 offen offset:2560
    buffer_load_dwordx2 v[34:35], v5, s[24:27], s41 offen offset:0
    buffer_load_dwordx2 v[36:37], v5, s[24:27], s41 offen offset:1280
    buffer_load_dwordx2 v[38:39], v5, s[28:31], 0 offen offset:0
    buffer_load_dwordx2 v[40:41], v5, s[28:31], 0 offen offset:1280
    buffer_load_dwordx2 v[42:43], v5, s[28:31], 0 offen offset:2560
    buffer_load_dwordx2 v[44:45], v5, s[28:31], s40 offen offset:0
    buffer_load_dwordx2 v[46:47], v5, s[28:31], s40 offen offset:1280
    buffer_load_dwordx2 v[48:49], v5, s[28:31], s40 offen offset:2560
    buffer_load_dwordx2 v[50:51], v5, s[28:31], s41 offen offset:0
    buffer_load_dwordx2 v[52:53], v5, s[28:31], s41 offen offset:1280
    buffer_load_dwordx2 v[54:55], v5, s[20:23], 0 offen offset:0
    buffer_load_dwordx2 v[56:57], v5, s[20:23], 0 offen offset:1280
    buffer_load_dwordx2 v[58:59], v5, s[20:23], 0 offen offset:2560
    buffer_load_dwordx2 v[60:61], v5, s[20:23], s40 offen offset:0
    buffer_load_dwordx2 v[62:63], v5, s[20:23], s40 offen offset:1280
    buffer_load_dwordx2 v[64:65], v5, s[20:23], s40 offen offset:2560
    buffer_load_dwordx2 v[66:67], v5, s[20:23], s41 offen offset:0
    buffer_load_dwordx2 v[68:69], v5, s[20:23], s41 offen offset:1280
    v_and_b32 v7, 7, v2
    v_xor_b32 v7, v7, v1
    v_lshlrev_b32 v7, 4, v7
    v_lshl_add_u32 v7, v2, 9, v7
    v_lshrrev_b32 v3, 3, v0
    v_and_b32 v4, 7, v0
    v_xor_b32 v6, v4, v1
    v_lshlrev_b32 v6, 4, v6
    v_lshl_add_u32 v6, v3, 7, v6
    v_add_u32 v3, s17, v3
    v_lshlrev_b32 v3, 12, v3
    v_lshl_add_u32 v4, v4, 3, s16
    v_lshlrev_b32 v4, 1, v4
    v_sub_u32 v2, v3, v4
    v_add_u32 v2, 4080, v2
    v_add_u32 v1, v3, v4
    v_add_u32 v1, 2621440, v1
    s_mov_b32 s44, 0x05040100
    s_mov_b32 s45, 0x07060302
    s_mov_b32 s46, 0x20000
    s_mov_b32 s47, 0x40000
    s_mov_b32 s52, 0x60000
    s_waitcnt vmcnt(16)
    v_lshlrev_b32 v70, 16, v8
    v_lshlrev_b32 v71, 16, v10
    v_and_b32 v72, 0xffff0000, v8
    v_and_b32 v73, 0xffff0000, v10
    v_lshlrev_b32 v74, 16, v9
    v_lshlrev_b32 v75, 16, v11
    v_and_b32 v76, 0xffff0000, v9
    v_and_b32 v77, 0xffff0000, v11
    v_lshlrev_b32 v78, 16, v12
    v_lshlrev_b32 v79, 16, v14
    v_and_b32 v80, 0xffff0000, v12
    v_and_b32 v81, 0xffff0000, v14
    v_lshlrev_b32 v82, 16, v13
    v_lshlrev_b32 v83, 16, v15
    v_and_b32 v84, 0xffff0000, v13
    v_and_b32 v85, 0xffff0000, v15
    v_lshlrev_b32 v88, 16, v16
    v_and_b32 v89, 0xffff0000, v16
    v_lshlrev_b32 v90, 16, v18
    v_and_b32 v91, 0xffff0000, v18
    v_lshlrev_b32 v92, 16, v20
    v_and_b32 v93, 0xffff0000, v20
    v_lshlrev_b32 v94, 16, v22
    v_and_b32 v95, 0xffff0000, v22
    v_lshlrev_b32 v96, 16, v24
    v_and_b32 v97, 0xffff0000, v24
    v_lshlrev_b32 v98, 16, v26
    v_and_b32 v99, 0xffff0000, v26
    v_lshlrev_b32 v100, 16, v28
    v_and_b32 v101, 0xffff0000, v28
    v_lshlrev_b32 v102, 16, v30
    v_and_b32 v103, 0xffff0000, v30
    v_lshlrev_b32 v104, 16, v32
    v_and_b32 v105, 0xffff0000, v32
    v_lshlrev_b32 v106, 16, v34
    v_and_b32 v107, 0xffff0000, v34
    v_lshlrev_b32 v108, 16, v36
    v_and_b32 v109, 0xffff0000, v36
    v_pk_mul_f32 v[110:111], v[88:89], v[76:77]
    v_pk_mul_f32 v[112:113], v[90:91], v[76:77]
    v_pk_mul_f32 v[114:115], v[92:93], v[76:77]
    v_pk_mul_f32 v[116:117], v[94:95], v[76:77]
    v_pk_mul_f32 v[118:119], v[96:97], v[76:77]
    v_pk_mul_f32 v[120:121], v[98:99], v[76:77]
    v_pk_mul_f32 v[122:123], v[100:101], v[76:77]
    v_pk_mul_f32 v[124:125], v[102:103], v[76:77]
    v_pk_fma_f32 v[110:111], v[90:91], v[74:75], v[110:111]
    v_pk_fma_f32 v[112:113], v[92:93], v[74:75], v[112:113]
    v_pk_fma_f32 v[114:115], v[94:95], v[74:75], v[114:115]
    v_pk_fma_f32 v[116:117], v[96:97], v[74:75], v[116:117]
    v_pk_fma_f32 v[118:119], v[98:99], v[74:75], v[118:119]
    v_pk_fma_f32 v[120:121], v[100:101], v[74:75], v[120:121]
    v_pk_fma_f32 v[122:123], v[102:103], v[74:75], v[122:123]
    v_pk_fma_f32 v[124:125], v[104:105], v[74:75], v[124:125]
    v_pk_fma_f32 v[110:111], v[92:93], v[72:73], v[110:111]
    v_pk_fma_f32 v[112:113], v[94:95], v[72:73], v[112:113]
    v_pk_fma_f32 v[114:115], v[96:97], v[72:73], v[114:115]
    v_pk_fma_f32 v[116:117], v[98:99], v[72:73], v[116:117]
    v_pk_fma_f32 v[118:119], v[100:101], v[72:73], v[118:119]
    v_pk_fma_f32 v[120:121], v[102:103], v[72:73], v[120:121]
    v_pk_fma_f32 v[122:123], v[104:105], v[72:73], v[122:123]
    v_pk_fma_f32 v[124:125], v[106:107], v[72:73], v[124:125]
    v_pk_fma_f32 v[110:111], v[94:95], v[70:71], v[110:111]
    v_pk_fma_f32 v[112:113], v[96:97], v[70:71], v[112:113]
    v_pk_fma_f32 v[114:115], v[98:99], v[70:71], v[114:115]
    v_pk_fma_f32 v[116:117], v[100:101], v[70:71], v[116:117]
    v_pk_fma_f32 v[118:119], v[102:103], v[70:71], v[118:119]
    v_pk_fma_f32 v[120:121], v[104:105], v[70:71], v[120:121]
    v_pk_fma_f32 v[122:123], v[106:107], v[70:71], v[122:123]
    v_pk_fma_f32 v[124:125], v[108:109], v[70:71], v[124:125]
    s_waitcnt vmcnt(8)
    v_lshlrev_b32 v88, 16, v38
    v_and_b32 v89, 0xffff0000, v38
    v_lshlrev_b32 v90, 16, v40
    v_and_b32 v91, 0xffff0000, v40
    v_lshlrev_b32 v92, 16, v42
    v_and_b32 v93, 0xffff0000, v42
    v_lshlrev_b32 v94, 16, v44
    v_and_b32 v95, 0xffff0000, v44
    v_lshlrev_b32 v96, 16, v46
    v_and_b32 v97, 0xffff0000, v46
    v_lshlrev_b32 v98, 16, v48
    v_and_b32 v99, 0xffff0000, v48
    v_lshlrev_b32 v100, 16, v50
    v_and_b32 v101, 0xffff0000, v50
    v_lshlrev_b32 v102, 16, v52
    v_and_b32 v103, 0xffff0000, v52
    v_pk_mul_f32 v[110:111], v[110:111], v[88:89]
    v_pk_mul_f32 v[112:113], v[112:113], v[90:91]
    v_pk_mul_f32 v[114:115], v[114:115], v[92:93]
    v_pk_mul_f32 v[116:117], v[116:117], v[94:95]
    v_pk_mul_f32 v[118:119], v[118:119], v[96:97]
    v_pk_mul_f32 v[120:121], v[120:121], v[98:99]
    v_pk_mul_f32 v[122:123], v[122:123], v[100:101]
    v_pk_mul_f32 v[124:125], v[124:125], v[102:103]
    v_cvt_pk_bf16_f32 v126, v124, v122
    v_cvt_pk_bf16_f32 v127, v120, v118
    v_cvt_pk_bf16_f32 v128, v116, v114
    v_cvt_pk_bf16_f32 v129, v112, v110
    ds_write_b128 v7, v[126:129] offset:0
    v_cvt_pk_bf16_f32 v130, v125, v123
    v_cvt_pk_bf16_f32 v131, v121, v119
    v_cvt_pk_bf16_f32 v132, v117, v115
    v_cvt_pk_bf16_f32 v133, v113, v111
    ds_write_b128 v7, v[130:133] offset:128
    v_lshlrev_b32 v88, 16, v17
    v_and_b32 v89, 0xffff0000, v17
    v_lshlrev_b32 v90, 16, v19
    v_and_b32 v91, 0xffff0000, v19
    v_lshlrev_b32 v92, 16, v21
    v_and_b32 v93, 0xffff0000, v21
    v_lshlrev_b32 v94, 16, v23
    v_and_b32 v95, 0xffff0000, v23
    v_lshlrev_b32 v96, 16, v25
    v_and_b32 v97, 0xffff0000, v25
    v_lshlrev_b32 v98, 16, v27
    v_and_b32 v99, 0xffff0000, v27
    v_lshlrev_b32 v100, 16, v29
    v_and_b32 v101, 0xffff0000, v29
    v_lshlrev_b32 v102, 16, v31
    v_and_b32 v103, 0xffff0000, v31
    v_lshlrev_b32 v104, 16, v33
    v_and_b32 v105, 0xffff0000, v33
    v_lshlrev_b32 v106, 16, v35
    v_and_b32 v107, 0xffff0000, v35
    v_lshlrev_b32 v108, 16, v37
    v_and_b32 v109, 0xffff0000, v37
    v_pk_mul_f32 v[110:111], v[88:89], v[84:85]
    v_pk_mul_f32 v[112:113], v[90:91], v[84:85]
    v_pk_mul_f32 v[114:115], v[92:93], v[84:85]
    v_pk_mul_f32 v[116:117], v[94:95], v[84:85]
    v_pk_mul_f32 v[118:119], v[96:97], v[84:85]
    v_pk_mul_f32 v[120:121], v[98:99], v[84:85]
    v_pk_mul_f32 v[122:123], v[100:101], v[84:85]
    v_pk_mul_f32 v[124:125], v[102:103], v[84:85]
    v_pk_fma_f32 v[110:111], v[90:91], v[82:83], v[110:111]
    v_pk_fma_f32 v[112:113], v[92:93], v[82:83], v[112:113]
    v_pk_fma_f32 v[114:115], v[94:95], v[82:83], v[114:115]
    v_pk_fma_f32 v[116:117], v[96:97], v[82:83], v[116:117]
    v_pk_fma_f32 v[118:119], v[98:99], v[82:83], v[118:119]
    v_pk_fma_f32 v[120:121], v[100:101], v[82:83], v[120:121]
    v_pk_fma_f32 v[122:123], v[102:103], v[82:83], v[122:123]
    v_pk_fma_f32 v[124:125], v[104:105], v[82:83], v[124:125]
    v_pk_fma_f32 v[110:111], v[92:93], v[80:81], v[110:111]
    v_pk_fma_f32 v[112:113], v[94:95], v[80:81], v[112:113]
    v_pk_fma_f32 v[114:115], v[96:97], v[80:81], v[114:115]
    v_pk_fma_f32 v[116:117], v[98:99], v[80:81], v[116:117]
    v_pk_fma_f32 v[118:119], v[100:101], v[80:81], v[118:119]
    v_pk_fma_f32 v[120:121], v[102:103], v[80:81], v[120:121]
    v_pk_fma_f32 v[122:123], v[104:105], v[80:81], v[122:123]
    v_pk_fma_f32 v[124:125], v[106:107], v[80:81], v[124:125]
    v_pk_fma_f32 v[110:111], v[94:95], v[78:79], v[110:111]
    v_pk_fma_f32 v[112:113], v[96:97], v[78:79], v[112:113]
    v_pk_fma_f32 v[114:115], v[98:99], v[78:79], v[114:115]
    v_pk_fma_f32 v[116:117], v[100:101], v[78:79], v[116:117]
    v_pk_fma_f32 v[118:119], v[102:103], v[78:79], v[118:119]
    v_pk_fma_f32 v[120:121], v[104:105], v[78:79], v[120:121]
    v_pk_fma_f32 v[122:123], v[106:107], v[78:79], v[122:123]
    v_pk_fma_f32 v[124:125], v[108:109], v[78:79], v[124:125]
    v_lshlrev_b32 v88, 16, v39
    v_and_b32 v89, 0xffff0000, v39
    v_lshlrev_b32 v90, 16, v41
    v_and_b32 v91, 0xffff0000, v41
    v_lshlrev_b32 v92, 16, v43
    v_and_b32 v93, 0xffff0000, v43
    v_lshlrev_b32 v94, 16, v45
    v_and_b32 v95, 0xffff0000, v45
    v_lshlrev_b32 v96, 16, v47
    v_and_b32 v97, 0xffff0000, v47
    v_lshlrev_b32 v98, 16, v49
    v_and_b32 v99, 0xffff0000, v49
    v_lshlrev_b32 v100, 16, v51
    v_and_b32 v101, 0xffff0000, v51
    v_lshlrev_b32 v102, 16, v53
    v_and_b32 v103, 0xffff0000, v53
    v_pk_mul_f32 v[110:111], v[110:111], v[88:89]
    v_pk_mul_f32 v[112:113], v[112:113], v[90:91]
    v_pk_mul_f32 v[114:115], v[114:115], v[92:93]
    v_pk_mul_f32 v[116:117], v[116:117], v[94:95]
    v_pk_mul_f32 v[118:119], v[118:119], v[96:97]
    v_pk_mul_f32 v[120:121], v[120:121], v[98:99]
    v_pk_mul_f32 v[122:123], v[122:123], v[100:101]
    v_pk_mul_f32 v[124:125], v[124:125], v[102:103]
    v_cvt_pk_bf16_f32 v134, v124, v122
    v_cvt_pk_bf16_f32 v135, v120, v118
    v_cvt_pk_bf16_f32 v136, v116, v114
    v_cvt_pk_bf16_f32 v137, v112, v110
    ds_write_b128 v7, v[134:137] offset:256
    v_cvt_pk_bf16_f32 v138, v125, v123
    v_cvt_pk_bf16_f32 v139, v121, v119
    v_cvt_pk_bf16_f32 v140, v117, v115
    v_cvt_pk_bf16_f32 v141, v113, v111
    ds_write_b128 v7, v[138:141] offset:384
    s_waitcnt vmcnt(0)
    v_perm_b32 v88, v56, v54, s44
    v_perm_b32 v89, v60, v58, s44
    v_perm_b32 v90, v64, v62, s44
    v_perm_b32 v91, v68, v66, s44
    ds_write_b128 v7, v[88:91] offset:16384
    v_perm_b32 v92, v56, v54, s45
    v_perm_b32 v93, v60, v58, s45
    v_perm_b32 v94, v64, v62, s45
    v_perm_b32 v95, v68, v66, s45
    ds_write_b128 v7, v[92:95] offset:16512
    v_perm_b32 v96, v57, v55, s44
    v_perm_b32 v97, v61, v59, s44
    v_perm_b32 v98, v65, v63, s44
    v_perm_b32 v99, v69, v67, s44
    ds_write_b128 v7, v[96:99] offset:16640
    v_perm_b32 v100, v57, v55, s45
    v_perm_b32 v101, v61, v59, s45
    v_perm_b32 v102, v65, v63, s45
    v_perm_b32 v103, v69, v67, s45
    ds_write_b128 v7, v[100:103] offset:16768
    s_waitcnt lgkmcnt(0)
    s_barrier
    ds_read_b128 v[8:11], v6 offset:0
    ds_read_b128 v[12:15], v6 offset:4096
    ds_read_b128 v[16:19], v6 offset:8192
    ds_read_b128 v[20:23], v6 offset:12288
    ds_read_b128 v[24:27], v6 offset:16384
    ds_read_b128 v[28:31], v6 offset:20480
    ds_read_b128 v[32:35], v6 offset:24576
    ds_read_b128 v[36:39], v6 offset:28672
    s_waitcnt lgkmcnt(7)
    buffer_store_dwordx4 v[8:11], v2, s[36:39], 0 offen
    s_waitcnt lgkmcnt(6)
    buffer_store_dwordx4 v[12:15], v2, s[36:39], s46 offen
    s_waitcnt lgkmcnt(5)
    buffer_store_dwordx4 v[16:19], v2, s[36:39], s47 offen
    s_waitcnt lgkmcnt(4)
    buffer_store_dwordx4 v[20:23], v2, s[36:39], s52 offen
    s_waitcnt lgkmcnt(3)
    buffer_store_dwordx4 v[24:27], v1, s[36:39], 0 offen
    s_waitcnt lgkmcnt(2)
    buffer_store_dwordx4 v[28:31], v1, s[36:39], s46 offen
    s_waitcnt lgkmcnt(1)
    buffer_store_dwordx4 v[32:35], v1, s[36:39], s47 offen
    s_waitcnt lgkmcnt(0)
    buffer_store_dwordx4 v[36:39], v1, s[36:39], s52 offen
    s_endpgm
L_k0_o:
    s_cmp_ge_u32 s2, 288
    s_cbranch_scc1 L_k0_p
    v_lshrrev_b32 v2, 6, v0
    v_and_b32 v1, 63, v0
    s_sub_u32 s14, s2, 160
    v_readfirstlane_b32 s15, v2
    s_lshl_b32 s14, s14, 2
    s_add_u32 s14, s14, s15
    s_mul_i32 s15, s14, 5120
    v_lshlrev_b32 v3, 4, v1
    v_lshlrev_b32 v4, 2, v1
    s_add_u32 s16, s15, 2560
    s_waitcnt lgkmcnt(0)
    s_mov_b32 s20, s4
    s_mov_b32 s21, s5
    s_mov_b32 s22, 2621440
    s_mov_b32 s23, 0x00020000
    s_mov_b32 s36, s12
    s_mov_b32 s37, s13
    s_mov_b32 s38, 8388608
    s_mov_b32 s39, 0x00020000
    buffer_load_dwordx4 v[10:13], v3, s[20:23], s15 offen offset:0
    buffer_load_dword v14, v4, s[20:23], s15 offen offset:1024
    buffer_load_dwordx4 v[16:19], v3, s[20:23], s15 offen offset:1280
    buffer_load_dword v20, v4, s[20:23], s15 offen offset:2304
    buffer_load_dwordx4 v[22:25], v3, s[20:23], s16 offen offset:0
    buffer_load_dword v26, v4, s[20:23], s16 offen offset:1024
    buffer_load_dwordx4 v[28:31], v3, s[20:23], s16 offen offset:1280
    buffer_load_dword v32, v4, s[20:23], s16 offen offset:2304
    s_mov_b32 s17, 0x3f803f80
    s_mov_b32 s49, 0x3acccccd
    v_mov_b32 v40, 0
    v_mov_b32 v41, 0
    v_mov_b32 v42, 0
    v_mov_b32 v43, 0
    v_mov_b32 v44, 0
    v_mov_b32 v45, 0
    v_mov_b32 v46, 0
    v_mov_b32 v47, 0
    s_waitcnt vmcnt(6)
    v_dot2_f32_bf16 v40, v10, s17, v40
    v_dot2_f32_bf16 v44, v10, v10, v44
    v_dot2_f32_bf16 v40, v11, s17, v40
    v_dot2_f32_bf16 v44, v11, v11, v44
    v_dot2_f32_bf16 v40, v12, s17, v40
    v_dot2_f32_bf16 v44, v12, v12, v44
    v_dot2_f32_bf16 v40, v13, s17, v40
    v_dot2_f32_bf16 v44, v13, v13, v44
    v_dot2_f32_bf16 v40, v14, s17, v40
    v_dot2_f32_bf16 v44, v14, v14, v44
    s_waitcnt vmcnt(4)
    v_dot2_f32_bf16 v41, v16, s17, v41
    v_dot2_f32_bf16 v45, v16, v16, v45
    v_dot2_f32_bf16 v41, v17, s17, v41
    v_dot2_f32_bf16 v45, v17, v17, v45
    v_dot2_f32_bf16 v41, v18, s17, v41
    v_dot2_f32_bf16 v45, v18, v18, v45
    v_dot2_f32_bf16 v41, v19, s17, v41
    v_dot2_f32_bf16 v45, v19, v19, v45
    v_dot2_f32_bf16 v41, v20, s17, v41
    v_dot2_f32_bf16 v45, v20, v20, v45
    s_waitcnt vmcnt(2)
    v_dot2_f32_bf16 v42, v22, s17, v42
    v_dot2_f32_bf16 v46, v22, v22, v46
    v_dot2_f32_bf16 v42, v23, s17, v42
    v_dot2_f32_bf16 v46, v23, v23, v46
    v_dot2_f32_bf16 v42, v24, s17, v42
    v_dot2_f32_bf16 v46, v24, v24, v46
    v_dot2_f32_bf16 v42, v25, s17, v42
    v_dot2_f32_bf16 v46, v25, v25, v46
    v_dot2_f32_bf16 v42, v26, s17, v42
    v_dot2_f32_bf16 v46, v26, v26, v46
    s_waitcnt vmcnt(0)
    v_dot2_f32_bf16 v43, v28, s17, v43
    v_dot2_f32_bf16 v47, v28, v28, v47
    v_dot2_f32_bf16 v43, v29, s17, v43
    v_dot2_f32_bf16 v47, v29, v29, v47
    v_dot2_f32_bf16 v43, v30, s17, v43
    v_dot2_f32_bf16 v47, v30, v30, v47
    v_dot2_f32_bf16 v43, v31, s17, v43
    v_dot2_f32_bf16 v47, v31, v31, v47
    v_dot2_f32_bf16 v43, v32, s17, v43
    v_dot2_f32_bf16 v47, v32, v32, v47
    s_nop 2
    s_nop 1
    v_add_f32_dpp v40, v40, v40 quad_perm:[1,0,3,2] row_mask:0xf bank_mask:0xf
    v_add_f32_dpp v41, v41, v41 quad_perm:[1,0,3,2] row_mask:0xf bank_mask:0xf
    v_add_f32_dpp v42, v42, v42 quad_perm:[1,0,3,2] row_mask:0xf bank_mask:0xf
    v_add_f32_dpp v43, v43, v43 quad_perm:[1,0,3,2] row_mask:0xf bank_mask:0xf
    v_add_f32_dpp v44, v44, v44 quad_perm:[1,0,3,2] row_mask:0xf bank_mask:0xf
    v_add_f32_dpp v45, v45, v45 quad_perm:[1,0,3,2] row_mask:0xf bank_mask:0xf
    v_add_f32_dpp v46, v46, v46 quad_perm:[1,0,3,2] row_mask:0xf bank_mask:0xf
    v_add_f32_dpp v47, v47, v47 quad_perm:[1,0,3,2] row_mask:0xf bank_mask:0xf
    s_nop 1
    v_add_f32_dpp v40, v40, v40 quad_perm:[2,3,0,1] row_mask:0xf bank_mask:0xf
    v_add_f32_dpp v41, v41, v41 quad_perm:[2,3,0,1] row_mask:0xf bank_mask:0xf
    v_add_f32_dpp v42, v42, v42 quad_perm:[2,3,0,1] row_mask:0xf bank_mask:0xf
    v_add_f32_dpp v43, v43, v43 quad_perm:[2,3,0,1] row_mask:0xf bank_mask:0xf
    v_add_f32_dpp v44, v44, v44 quad_perm:[2,3,0,1] row_mask:0xf bank_mask:0xf
    v_add_f32_dpp v45, v45, v45 quad_perm:[2,3,0,1] row_mask:0xf bank_mask:0xf
    v_add_f32_dpp v46, v46, v46 quad_perm:[2,3,0,1] row_mask:0xf bank_mask:0xf
    v_add_f32_dpp v47, v47, v47 quad_perm:[2,3,0,1] row_mask:0xf bank_mask:0xf
    s_nop 1
    v_add_f32_dpp v40, v40, v40 row_half_mirror row_mask:0xf bank_mask:0xf
    v_add_f32_dpp v41, v41, v41 row_half_mirror row_mask:0xf bank_mask:0xf
    v_add_f32_dpp v42, v42, v42 row_half_mirror row_mask:0xf bank_mask:0xf
    v_add_f32_dpp v43, v43, v43 row_half_mirror row_mask:0xf bank_mask:0xf
    v_add_f32_dpp v44, v44, v44 row_half_mirror row_mask:0xf bank_mask:0xf
    v_add_f32_dpp v45, v45, v45 row_half_mirror row_mask:0xf bank_mask:0xf
    v_add_f32_dpp v46, v46, v46 row_half_mirror row_mask:0xf bank_mask:0xf
    v_add_f32_dpp v47, v47, v47 row_half_mirror row_mask:0xf bank_mask:0xf
    s_nop 1
    v_add_f32_dpp v40, v40, v40 row_mirror row_mask:0xf bank_mask:0xf
    v_add_f32_dpp v41, v41, v41 row_mirror row_mask:0xf bank_mask:0xf
    v_add_f32_dpp v42, v42, v42 row_mirror row_mask:0xf bank_mask:0xf
    v_add_f32_dpp v43, v43, v43 row_mirror row_mask:0xf bank_mask:0xf
    v_add_f32_dpp v44, v44, v44 row_mirror row_mask:0xf bank_mask:0xf
    v_add_f32_dpp v45, v45, v45 row_mirror row_mask:0xf bank_mask:0xf
    v_add_f32_dpp v46, v46, v46 row_mirror row_mask:0xf bank_mask:0xf
    v_add_f32_dpp v47, v47, v47 row_mirror row_mask:0xf bank_mask:0xf
    s_nop 1
    v_add_f32_dpp v40, v40, v40 row_bcast:15 row_mask:0xa bank_mask:0xf
    v_add_f32_dpp v41, v41, v41 row_bcast:15 row_mask:0xa bank_mask:0xf
    v_add_f32_dpp v42, v42, v42 row_bcast:15 row_mask:0xa bank_mask:0xf
    v_add_f32_dpp v43, v43, v43 row_bcast:15 row_mask:0xa bank_mask:0xf
    v_add_f32_dpp v44, v44, v44 row_bcast:15 row_mask:0xa bank_mask:0xf
    v_add_f32_dpp v45, v45, v45 row_bcast:15 row_mask:0xa bank_mask:0xf
    v_add_f32_dpp v46, v46, v46 row_bcast:15 row_mask:0xa bank_mask:0xf
    v_add_f32_dpp v47, v47, v47 row_bcast:15 row_mask:0xa bank_mask:0xf
    s_nop 1
    v_add_f32_dpp v40, v40, v40 row_bcast:31 row_mask:0xc bank_mask:0xf
    v_add_f32_dpp v41, v41, v41 row_bcast:31 row_mask:0xc bank_mask:0xf
    v_add_f32_dpp v42, v42, v42 row_bcast:31 row_mask:0xc bank_mask:0xf
    v_add_f32_dpp v43, v43, v43 row_bcast:31 row_mask:0xc bank_mask:0xf
    v_add_f32_dpp v44, v44, v44 row_bcast:31 row_mask:0xc bank_mask:0xf
    v_add_f32_dpp v45, v45, v45 row_bcast:31 row_mask:0xc bank_mask:0xf
    v_add_f32_dpp v46, v46, v46 row_bcast:31 row_mask:0xc bank_mask:0xf
    v_add_f32_dpp v47, v47, v47 row_bcast:31 row_mask:0xc bank_mask:0xf
    s_nop 1
    v_mul_f32 v40, s49, v40
    v_mul_f32 v44, s49, v44
    v_fma_f32 v44, -v40, v40, v44
    v_max_f32 v44, 0, v44
    v_cvt_pk_bf16_f32 v44, v44, v44
    v_and_b32 v44, 0xffff0000, v44
    v_add_f32 v44, 0x3727c5ac, v44
    v_cvt_pk_bf16_f32 v44, v44, v44
    v_and_b32 v44, 0xffff0000, v44
    v_sqrt_f32 v44, v44
    s_nop 0
    v_cvt_pk_bf16_f32 v48, v40, v44
    v_and_b32 v52, 0xffff0000, v48
    v_lshlrev_b32 v48, 16, v48
    v_rcp_f32 v52, v52
    v_mul_f32 v41, s49, v41
    v_mul_f32 v45, s49, v45
    v_fma_f32 v45, -v41, v41, v45
    v_max_f32 v45, 0, v45
    v_cvt_pk_bf16_f32 v45, v45, v45
    v_and_b32 v45, 0xffff0000, v45
    v_add_f32 v45, 0x3727c5ac, v45
    v_cvt_pk_bf16_f32 v45, v45, v45
    v_and_b32 v45, 0xffff0000, v45
    v_sqrt_f32 v45, v45
    s_nop 0
    v_cvt_pk_bf16_f32 v49, v41, v45
    v_and_b32 v53, 0xffff0000, v49
    v_lshlrev_b32 v49, 16, v49
    v_rcp_f32 v53, v53
    v_mul_f32 v42, s49, v42
    v_mul_f32 v46, s49, v46
    v_fma_f32 v46, -v42, v42, v46
    v_max_f32 v46, 0, v46
    v_cvt_pk_bf16_f32 v46, v46, v46
    v_and_b32 v46, 0xffff0000, v46
    v_add_f32 v46, 0x3727c5ac, v46
    v_cvt_pk_bf16_f32 v46, v46, v46
    v_and_b32 v46, 0xffff0000, v46
    v_sqrt_f32 v46, v46
    s_nop 0
    v_cvt_pk_bf16_f32 v50, v42, v46
    v_and_b32 v54, 0xffff0000, v50
    v_lshlrev_b32 v50, 16, v50
    v_rcp_f32 v54, v54
    v_mul_f32 v43, s49, v43
    v_mul_f32 v47, s49, v47
    v_fma_f32 v47, -v43, v43, v47
    v_max_f32 v47, 0, v47
    v_cvt_pk_bf16_f32 v47, v47, v47
    v_and_b32 v47, 0xffff0000, v47
    v_add_f32 v47, 0x3727c5ac, v47
    v_cvt_pk_bf16_f32 v47, v47, v47
    v_and_b32 v47, 0xffff0000, v47
    v_sqrt_f32 v47, v47
    s_nop 0
    v_cvt_pk_bf16_f32 v51, v43, v47
    v_and_b32 v55, 0xffff0000, v51
    v_lshlrev_b32 v51, 16, v51
    v_rcp_f32 v55, v55
    s_lshl_b32 s14, s14, 4
    s_add_u32 s14, s14, 7864320
    v_mov_b32 v3, 0
    s_mov_b32 exec_lo, 0
    s_mov_b32 exec_hi, 0x80000000
    buffer_store_dwordx4 v[48:51], v3, s[36:39], s14 offen
    s_add_u32 s14, s14, 8192
    buffer_store_dwordx4 v[52:55], v3, s[36:39], s14 offen
    s_endpgm
L_k0_p:
    s_sub_u32 s14, s2, 288
    s_cmp_ge_u32 s14, 60
    s_cselect_b32 s15, 60, 0
    s_sub_u32 s15, s14, s15
    s_lshl_b32 s15, s15, 8
    s_waitcnt lgkmcnt(0)
    s_cmp_ge_u32 s14, 60
    s_cselect_b32 s48, s50, s48
    s_cselect_b32 s49, s51, s49
    s_cselect_b32 s16, 6144, 0
    s_mov_b32 s20, s48
    s_mov_b32 s21, s49
    s_mov_b32 s22, 1966080
    s_mov_b32 s23, 0x00020000
    s_add_u32 s36, s12, 18874368
    s_addc_u32 s37, s13, 0
    s_mov_b32 s38, 4194304
    s_mov_b32 s39, 0x00020000
    v_add_u32 v1, s15, v0
    v_mul_u32_u24 v2, 21846, v1
    v_lshrrev_b32 v2, 22, v2
    v_mul_u32_u24 v3, 192, v2
    v_sub_u32 v1, v1, v3
    v_lshrrev_b32 v3, 2, v2
    v_and_b32 v2, 3, v2
    v_lshlrev_b32 v4, 3, v3
    v_add_u32 v4, v4, v2
    v_mul_u32_u24 v4, 12288, v4
    v_lshl_add_u32 v4, v1, 4, v4
    s_movk_i32 s60, 3072
    s_movk_i32 s61, 6144
    s_movk_i32 s62, 9216
    v_add_u32 v5, 49152, v4
    buffer_load_dwordx4 v[10:13], v4, s[20:23], 0 offen
    buffer_load_dwordx4 v[14:17], v4, s[20:23], s60 offen
    buffer_load_dwordx4 v[18:21], v4, s[20:23], s61 offen
    buffer_load_dwordx4 v[22:25], v4, s[20:23], s62 offen
    buffer_load_dwordx4 v[26:29], v5, s[20:23], 0 offen
    buffer_load_dwordx4 v[30:33], v5, s[20:23], s60 offen
    buffer_load_dwordx4 v[34:37], v5, s[20:23], s61 offen
    buffer_load_dwordx4 v[38:41], v5, s[20:23], s62 offen
    v_lshrrev_b32 v6, 1, v1
    v_mul_u32_u24 v7, 10923, v6
    v_lshrrev_b32 v7, 16, v7
    v_mul_u32_u24 v8, 6, v7
    v_sub_u32 v6, v6, v8
    v_mad_u32_u24 v7, v7, 20, v3
    v_mad_u32_u24 v7, v7, 12, v6
    v_lshlrev_b32 v7, 10, v7
    v_lshl_add_u32 v7, v2, 8, v7
    v_and_b32 v1, 1, v1
    v_lshl_add_u32 v7, v1, 7, v7
    s_mov_b32 s60, 0x05040100
    s_mov_b32 s61, 0x07060302
    v_lshrrev_b32 v1, 6, v0
    v_mul_u32_u24 v1, 8448, v1
    v_and_b32 v2, 63, v0
    v_and_b32 v3, 7, v0
    v_bfe_u32 v4, v0, 3, 3
    v_lshl_add_u32 v5, v2, 2, v1
    ds_write_b32 v5, v7 offset:8192
    v_lshl_add_u32 v5, v4, 2, v1
    v_xor_b32 v6, v3, v4
    v_lshl_add_u32 v6, v6, 4, v1
    v_lshl_add_u32 v6, v4, 7, v6
    v_lshl_add_u32 v1, v2, 7, v1
    v_lshlrev_b32 v3, 4, v3
    v_add_u32 v1, v1, v3
    s_waitcnt lgkmcnt(0)
    ds_read_b32 v80, v5 offset:8192
    ds_read_b32 v81, v5 offset:8224
    ds_read_b32 v82, v5 offset:8256
    ds_read_b32 v83, v5 offset:8288
    ds_read_b32 v84, v5 offset:8320
    ds_read_b32 v85, v5 offset:8352
    ds_read_b32 v86, v5 offset:8384
    ds_read_b32 v87, v5 offset:8416
    s_waitcnt vmcnt(0)
    v_perm_b32 v42, v14, v10, s60
    v_perm_b32 v43, v22, v18, s60
    v_perm_b32 v44, v30, v26, s60
    v_perm_b32 v45, v38, v34, s60
    v_xor_b32 v2, 0, v1
    ds_write_b128 v2, v[42:45]
    v_perm_b32 v46, v14, v10, s61
    v_perm_b32 v47, v22, v18, s61
    v_perm_b32 v48, v30, v26, s61
    v_perm_b32 v49, v38, v34, s61
    v_xor_b32 v2, 16, v1
    ds_write_b128 v2, v[46:49]
    v_perm_b32 v50, v15, v11, s60
    v_perm_b32 v51, v23, v19, s60
    v_perm_b32 v52, v31, v27, s60
    v_perm_b32 v53, v39, v35, s60
    v_xor_b32 v2, 32, v1
    ds_write_b128 v2, v[50:53]
    v_perm_b32 v54, v15, v11, s61
    v_perm_b32 v55, v23, v19, s61
    v_perm_b32 v56, v31, v27, s61
    v_perm_b32 v57, v39, v35, s61
    v_xor_b32 v2, 48, v1
    ds_write_b128 v2, v[54:57]
    v_perm_b32 v58, v16, v12, s60
    v_perm_b32 v59, v24, v20, s60
    v_perm_b32 v60, v32, v28, s60
    v_perm_b32 v61, v40, v36, s60
    v_xor_b32 v2, 64, v1
    ds_write_b128 v2, v[58:61]
    v_perm_b32 v62, v16, v12, s61
    v_perm_b32 v63, v24, v20, s61
    v_perm_b32 v64, v32, v28, s61
    v_perm_b32 v65, v40, v36, s61
    v_xor_b32 v2, 80, v1
    ds_write_b128 v2, v[62:65]
    v_perm_b32 v66, v17, v13, s60
    v_perm_b32 v67, v25, v21, s60
    v_perm_b32 v68, v33, v29, s60
    v_perm_b32 v69, v41, v37, s60
    v_xor_b32 v2, 96, v1
    ds_write_b128 v2, v[66:69]
    v_perm_b32 v70, v17, v13, s61
    v_perm_b32 v71, v25, v21, s61
    v_perm_b32 v72, v33, v29, s61
    v_perm_b32 v73, v41, v37, s61
    v_xor_b32 v2, 112, v1
    ds_write_b128 v2, v[70:73]
    s_waitcnt lgkmcnt(0)
    ds_read_b128 v[10:13], v6 offset:0
    v_add_u32 v80, v80, v3
    ds_read_b128 v[14:17], v6 offset:1024
    v_add_u32 v81, v81, v3
    ds_read_b128 v[18:21], v6 offset:2048
    v_add_u32 v82, v82, v3
    ds_read_b128 v[22:25], v6 offset:3072
    v_add_u32 v83, v83, v3
    ds_read_b128 v[26:29], v6 offset:4096
    v_add_u32 v84, v84, v3
    ds_read_b128 v[30:33], v6 offset:5120
    v_add_u32 v85, v85, v3
    ds_read_b128 v[34:37], v6 offset:6144
    v_add_u32 v86, v86, v3
    ds_read_b128 v[38:41], v6 offset:7168
    v_add_u32 v87, v87, v3
    s_waitcnt lgkmcnt(7)
    buffer_store_dwordx4 v[10:13], v80, s[36:39], s16 offen
    s_waitcnt lgkmcnt(6)
    buffer_store_dwordx4 v[14:17], v81, s[36:39], s16 offen
    s_waitcnt lgkmcnt(5)
    buffer_store_dwordx4 v[18:21], v82, s[36:39], s16 offen
    s_waitcnt lgkmcnt(4)
    buffer_store_dwordx4 v[22:25], v83, s[36:39], s16 offen
    s_waitcnt lgkmcnt(3)
    buffer_store_dwordx4 v[26:29], v84, s[36:39], s16 offen
    s_waitcnt lgkmcnt(2)
    buffer_store_dwordx4 v[30:33], v85, s[36:39], s16 offen
    s_waitcnt lgkmcnt(1)
    buffer_store_dwordx4 v[34:37], v86, s[36:39], s16 offen
    s_waitcnt lgkmcnt(0)
    buffer_store_dwordx4 v[38:41], v87, s[36:39], s16 offen
    s_endpgm
L_k0_end:
    s_endpgm
.p2align 8
.globl k1_kernel
.type k1_kernel,@function
k1_kernel:
    s_cmp_ge_u32 s2, 748
    s_cbranch_scc1 L_k1_end
    s_load_dwordx4 s[4:7], s[0:1], 32
    s_load_dwordx2 s[8:9], s[0:1], 72
    s_load_dwordx2 s[12:13], s[0:1], 96
    v_and_b32 v1, 63, v0
    v_lshrrev_b32 v2, 6, v0
    s_cmp_lt_u32 s2, 108
    s_cbranch_scc1 L_k1_cs
    s_sub_u32 s14, s2, 108
    s_lshl_b32 s15, s14, 12
    s_lshl_b32 s16, s14, 1
    s_and_b32 s17, s16, 2
    s_and_b32 s16, s16, -4
    v_readfirstlane_b32 s18, v2
    v_lshlrev_b32 v3, 4, v0
    v_subrev_u32 v4, 32, v3
    v_subrev_u32 v5, 16, v3
    v_and_b32 v6, 15, v0
    v_bfe_u32 v7, v0, 4, 2
    s_waitcnt lgkmcnt(0)
    s_load_dword s19, s[6:7], s16
    s_add_u32 s20, s4, s15
    s_addc_u32 s21, s5, 0
    s_mov_b32 s22, 4096
    s_mov_b32 s23, 0x00020000
    s_add_u32 s24, s12, s15
    s_addc_u32 s25, s13, 0
    s_mov_b32 s26, 4096
    s_mov_b32 s27, 0x00020000
    s_mov_b32 s28, s12
    s_mov_b32 s29, s13
    s_mov_b32 s30, 8388608
    s_mov_b32 s31, 0x00020000
    s_cmp_lg_u32 s18, 0
    s_cbranch_scc1 L_k1_n0
    s_mov_b64 exec, 3
    buffer_load_dwordx4 v[42:45], v3, s[20:23], 0 offen offset:4064
    buffer_load_dwordx4 v[46:49], v3, s[20:23], 0 offen offset:4080
    s_mov_b64 exec, -1
L_k1_n0:
    buffer_load_dwordx4 v[10:13], v4, s[20:23], 0 offen
    buffer_load_dwordx4 v[14:17], v5, s[20:23], 0 offen
    v_lshlrev_b32 v8, 4, v7
    v_lshl_add_u32 v8, v2, 7, v8
    v_lshlrev_b32 v9, 5, v6
    v_sub_u32 v8, v8, v9
    v_add_u32 v8, 33504, v8
    s_lshl_b32 s35, s18, 10
    s_add_u32 m0, s35, 33024
    v_add_u32 v9, 4096, v3
    buffer_load_dwordx4 v3, s[24:27], 0 offen lds
    s_mov_b32 m0, 37120
    s_nop 0
    buffer_load_dwordx4 v9, s[24:27], 0 offen lds
    v_lshlrev_b32 v9, 4, v6
    v_lshl_add_u32 v9, v7, 2, v9
    v_lshl_add_u32 v9, v2, 9, v9
    v_lshlrev_b32 v154, 1, v9
    v_sub_u32 v155, 3576, v154
    v_lshlrev_b32 v156, 2, v9
    s_add_u32 s32, s15, 2621440
    s_add_u32 s33, s15, 5242880
    s_mov_b32 s34, 7864320
    buffer_load_dwordx2 v[138:139], v154, s[28:31], s32 offen
    buffer_load_dwordx2 v[140:141], v154, s[28:31], s32 offen offset:512
    buffer_load_dwordx2 v[142:143], v155, s[24:27], 0 offen offset:512
    buffer_load_dwordx2 v[144:145], v155, s[24:27], 0 offen
    s_mov_b32 s36, 7872512
    buffer_load_dwordx4 v[146:149], v156, s[28:31], s34 offen
    buffer_load_dwordx4 v[150:153], v156, s[28:31], s34 offen offset:1024
    buffer_load_dwordx4 v[158:161], v156, s[28:31], s36 offen
    buffer_load_dwordx4 v[162:165], v156, s[28:31], s36 offen offset:1024
    s_waitcnt vmcnt(10)
    v_mov_b32 v18, v11
    v_mov_b32 v19, v12
    v_mov_b32 v20, v13
    v_mov_b32 v21, v14
    v_mov_b32 v22, v15
    v_mov_b32 v23, v16
    v_alignbit_b32 v26, v11, v10, 16
    v_alignbit_b32 v27, v12, v11, 16
    v_alignbit_b32 v28, v13, v12, 16
    v_alignbit_b32 v29, v14, v13, 16
    v_alignbit_b32 v30, v15, v14, 16
    v_alignbit_b32 v31, v16, v15, 16
    v_alignbit_b32 v32, v12, v11, 16
    v_alignbit_b32 v33, v13, v12, 16
    v_alignbit_b32 v34, v14, v13, 16
    v_alignbit_b32 v35, v15, v14, 16
    v_alignbit_b32 v36, v16, v15, 16
    v_alignbit_b32 v37, v17, v16, 16
    ds_write_b128 v3, v[10:13] offset:0
    ds_write_b128 v3, v[26:29] offset:4128
    ds_write_b128 v3, v[18:21] offset:8256
    ds_write_b128 v3, v[32:35] offset:12384
    ds_write_b128 v3, v[12:15] offset:16512
    ds_write_b128 v3, v[28:31] offset:20640
    ds_write_b128 v3, v[20:23] offset:24768
    ds_write_b128 v3, v[34:37] offset:28896
    s_cmp_lg_u32 s18, 0
    s_cbranch_scc1 L_k1_nx
    s_mov_b64 exec, 3
    s_nop 2
    v_mov_b32 v10, v42
    v_mov_b32 v11, v43
    v_mov_b32 v12, v44
    v_mov_b32 v13, v45
    v_mov_b32 v14, v46
    v_mov_b32 v15, v47
    v_mov_b32 v16, v48
    v_mov_b32 v17, v49
    v_mov_b32 v18, v11
    v_mov_b32 v19, v12
    v_mov_b32 v20, v13
    v_mov_b32 v21, v14
    v_mov_b32 v22, v15
    v_mov_b32 v23, v16
    v_alignbit_b32 v26, v11, v10, 16
    v_alignbit_b32 v27, v12, v11, 16
    v_alignbit_b32 v28, v13, v12, 16
    v_alignbit_b32 v29, v14, v13, 16
    v_alignbit_b32 v30, v15, v14, 16
    v_alignbit_b32 v31, v16, v15, 16
    v_alignbit_b32 v32, v12, v11, 16
    v_alignbit_b32 v33, v13, v12, 16
    v_alignbit_b32 v34, v14, v13, 16
    v_alignbit_b32 v35, v15, v14, 16
    v_alignbit_b32 v36, v16, v15, 16
    v_alignbit_b32 v37, v17, v16, 16
    ds_write_b128 v3, v[10:13] offset:4096
    ds_write_b128 v3, v[26:29] offset:8224
    ds_write_b128 v3, v[18:21] offset:12352
    ds_write_b128 v3, v[32:35] offset:16480
    ds_write_b128 v3, v[12:15] offset:20608
    ds_write_b128 v3, v[28:31] offset:24736
    ds_write_b128 v3, v[20:23] offset:28864
    ds_write_b128 v3, v[34:37] offset:32992
    s_mov_b64 exec, -1
L_k1_nx:
    v_add_u32 v4, 1, v6
    v_and_b32 v5, 7, v4
    v_lshrrev_b32 v4, 3, v4
    v_add_u32 v4, v4, v7
    v_lshlrev_b32 v4, 4, v4
    v_mov_b32 v1, 4128
    v_mad_u32_u24 v4, v5, v1, v4
    v_lshl_add_u32 v4, v2, 7, v4
    s_waitcnt lgkmcnt(0) vmcnt(8)
    s_barrier
    ds_read_b128 v[10:13], v4 offset:0
    ds_read_b128 v[14:17], v4 offset:512
    ds_read_b128 v[18:21], v4 offset:1024
    ds_read_b128 v[22:25], v4 offset:1536
    ds_read_b128 v[74:77], v8 offset:3584
    ds_read_b128 v[78:81], v8 offset:3072
    ds_read_b128 v[82:85], v8 offset:2560
    ds_read_b128 v[86:89], v8 offset:2048
    ds_read_b128 v[90:93], v8 offset:1536
    ds_read_b128 v[94:97], v8 offset:1024
    ds_read_b128 v[98:101], v8 offset:512
    ds_read_b128 v[102:105], v8 offset:0
    s_waitcnt lgkmcnt(0)
    ds_read_b128 v[26:29], v4 offset:2048
    ds_read_b128 v[30:33], v4 offset:2560
    ds_read_b128 v[34:37], v4 offset:3072
    ds_read_b128 v[38:41], v4 offset:3584
    ds_read_b128 v[106:109], v8 offset:3648
    ds_read_b128 v[110:113], v8 offset:3136
    ds_read_b128 v[114:117], v8 offset:2624
    ds_read_b128 v[118:121], v8 offset:2112
    ds_read_b128 v[122:125], v8 offset:1600
    ds_read_b128 v[126:129], v8 offset:1088
    ds_read_b128 v[130:133], v8 offset:576
    ds_read_b128 v[134:137], v8 offset:64
    v_mfma_f32_16x16x32_bf16 v[42:45], v[10:13], v[74:77], 0
    v_mfma_f32_16x16x32_bf16 v[46:49], v[10:13], v[78:81], 0
    v_mfma_f32_16x16x32_bf16 v[50:53], v[10:13], v[82:85], 0
    v_mfma_f32_16x16x32_bf16 v[54:57], v[10:13], v[86:89], 0
    v_mfma_f32_16x16x32_bf16 v[58:61], v[10:13], v[90:93], 0
    v_mfma_f32_16x16x32_bf16 v[62:65], v[10:13], v[94:97], 0
    v_mfma_f32_16x16x32_bf16 v[66:69], v[10:13], v[98:101], 0
    v_mfma_f32_16x16x32_bf16 v[70:73], v[10:13], v[102:105], 0
    v_mfma_f32_16x16x32_bf16 v[46:49], v[14:17], v[74:77], v[46:49]
    v_mfma_f32_16x16x32_bf16 v[50:53], v[14:17], v[78:81], v[50:53]
    v_mfma_f32_16x16x32_bf16 v[54:57], v[14:17], v[82:85], v[54:57]
    v_mfma_f32_16x16x32_bf16 v[58:61], v[14:17], v[86:89], v[58:61]
    v_mfma_f32_16x16x32_bf16 v[62:65], v[14:17], v[90:93], v[62:65]
    v_mfma_f32_16x16x32_bf16 v[66:69], v[14:17], v[94:97], v[66:69]
    v_mfma_f32_16x16x32_bf16 v[70:73], v[14:17], v[98:101], v[70:73]
    v_mfma_f32_16x16x32_bf16 v[50:53], v[18:21], v[74:77], v[50:53]
    v_mfma_f32_16x16x32_bf16 v[54:57], v[18:21], v[78:81], v[54:57]
    v_mfma_f32_16x16x32_bf16 v[58:61], v[18:21], v[82:85], v[58:61]
    v_mfma_f32_16x16x32_bf16 v[62:65], v[18:21], v[86:89], v[62:65]
    v_mfma_f32_16x16x32_bf16 v[66:69], v[18:21], v[90:93], v[66:69]
    v_mfma_f32_16x16x32_bf16 v[70:73], v[18:21], v[94:97], v[70:73]
    v_mfma_f32_16x16x32_bf16 v[54:57], v[22:25], v[74:77], v[54:57]
    v_mfma_f32_16x16x32_bf16 v[58:61], v[22:25], v[78:81], v[58:61]
    v_mfma_f32_16x16x32_bf16 v[62:65], v[22:25], v[82:85], v[62:65]
    v_mfma_f32_16x16x32_bf16 v[66:69], v[22:25], v[86:89], v[66:69]
    v_mfma_f32_16x16x32_bf16 v[70:73], v[22:25], v[90:93], v[70:73]
    s_waitcnt lgkmcnt(8)
    ds_read_b128 v[10:13], v4 offset:64
    ds_read_b128 v[14:17], v4 offset:576
    ds_read_b128 v[18:21], v4 offset:1088
    ds_read_b128 v[22:25], v4 offset:1600
    v_mfma_f32_16x16x32_bf16 v[58:61], v[26:29], v[74:77], v[58:61]
    v_mfma_f32_16x16x32_bf16 v[62:65], v[26:29], v[78:81], v[62:65]
    v_mfma_f32_16x16x32_bf16 v[66:69], v[26:29], v[82:85], v[66:69]
    v_mfma_f32_16x16x32_bf16 v[70:73], v[26:29], v[86:89], v[70:73]
    v_mfma_f32_16x16x32_bf16 v[62:65], v[30:33], v[74:77], v[62:65]
    v_mfma_f32_16x16x32_bf16 v[66:69], v[30:33], v[78:81], v[66:69]
    v_mfma_f32_16x16x32_bf16 v[70:73], v[30:33], v[82:85], v[70:73]
    v_mfma_f32_16x16x32_bf16 v[66:69], v[34:37], v[74:77], v[66:69]
    v_mfma_f32_16x16x32_bf16 v[70:73], v[34:37], v[78:81], v[70:73]
    v_mfma_f32_16x16x32_bf16 v[70:73], v[38:41], v[74:77], v[70:73]
    s_waitcnt lgkmcnt(0)
    ds_read_b128 v[26:29], v4 offset:2112
    ds_read_b128 v[30:33], v4 offset:2624
    ds_read_b128 v[34:37], v4 offset:3136
    ds_read_b128 v[38:41], v4 offset:3648
    v_mfma_f32_16x16x32_bf16 v[42:45], v[10:13], v[106:109], v[42:45]
    v_mfma_f32_16x16x32_bf16 v[46:49], v[10:13], v[110:113], v[46:49]
    v_mfma_f32_16x16x32_bf16 v[50:53], v[10:13], v[114:117], v[50:53]
    v_mfma_f32_16x16x32_bf16 v[54:57], v[10:13], v[118:121], v[54:57]
    v_mfma_f32_16x16x32_bf16 v[58:61], v[10:13], v[122:125], v[58:61]
    v_mfma_f32_16x16x32_bf16 v[62:65], v[10:13], v[126:129], v[62:65]
    v_mfma_f32_16x16x32_bf16 v[66:69], v[10:13], v[130:133], v[66:69]
    v_mfma_f32_16x16x32_bf16 v[70:73], v[10:13], v[134:137], v[70:73]
    v_mfma_f32_16x16x32_bf16 v[46:49], v[14:17], v[106:109], v[46:49]
    v_mfma_f32_16x16x32_bf16 v[50:53], v[14:17], v[110:113], v[50:53]
    v_mfma_f32_16x16x32_bf16 v[54:57], v[14:17], v[114:117], v[54:57]
    v_mfma_f32_16x16x32_bf16 v[58:61], v[14:17], v[118:121], v[58:61]
    v_mfma_f32_16x16x32_bf16 v[62:65], v[14:17], v[122:125], v[62:65]
    v_mfma_f32_16x16x32_bf16 v[66:69], v[14:17], v[126:129], v[66:69]
    v_mfma_f32_16x16x32_bf16 v[70:73], v[14:17], v[130:133], v[70:73]
    v_mfma_f32_16x16x32_bf16 v[50:53], v[18:21], v[106:109], v[50:53]
    v_mfma_f32_16x16x32_bf16 v[54:57], v[18:21], v[110:113], v[54:57]
    v_mfma_f32_16x16x32_bf16 v[58:61], v[18:21], v[114:117], v[58:61]
    v_mfma_f32_16x16x32_bf16 v[62:65], v[18:21], v[118:121], v[62:65]
    v_mfma_f32_16x16x32_bf16 v[66:69], v[18:21], v[122:125], v[66:69]
    v_mfma_f32_16x16x32_bf16 v[70:73], v[18:21], v[126:129], v[70:73]
    v_mfma_f32_16x16x32_bf16 v[54:57], v[22:25], v[106:109], v[54:57]
    v_mfma_f32_16x16x32_bf16 v[58:61], v[22:25], v[110:113], v[58:61]
    v_mfma_f32_16x16x32_bf16 v[62:65], v[22:25], v[114:117], v[62:65]
    v_mfma_f32_16x16x32_bf16 v[66:69], v[22:25], v[118:121], v[66:69]
    v_mfma_f32_16x16x32_bf16 v[70:73], v[22:25], v[122:125], v[70:73]
    s_waitcnt lgkmcnt(0)
    v_mfma_f32_16x16x32_bf16 v[58:61], v[26:29], v[106:109], v[58:61]
    v_mfma_f32_16x16x32_bf16 v[62:65], v[26:29], v[110:113], v[62:65]
    v_mfma_f32_16x16x32_bf16 v[66:69], v[26:29], v[114:117], v[66:69]
    v_mfma_f32_16x16x32_bf16 v[70:73], v[26:29], v[118:121], v[70:73]
    v_mfma_f32_16x16x32_bf16 v[62:65], v[30:33], v[106:109], v[62:65]
    v_mfma_f32_16x16x32_bf16 v[66:69], v[30:33], v[110:113], v[66:69]
    v_mfma_f32_16x16x32_bf16 v[70:73], v[30:33], v[114:117], v[70:73]
    v_mfma_f32_16x16x32_bf16 v[66:69], v[34:37], v[106:109], v[66:69]
    v_mfma_f32_16x16x32_bf16 v[70:73], v[34:37], v[110:113], v[70:73]
    v_mfma_f32_16x16x32_bf16 v[70:73], v[38:41], v[106:109], v[70:73]
    v_and_b32 v1, 63, v0
    v_lshlrev_b32 v1, 4, v1
    v_lshl_add_u32 v5, v2, 13, v1
    v_lshl_add_u32 v1, v2, 11, v1
    s_nop 4
    s_barrier
    ds_write_b128 v5, v[42:45] offset:0
    ds_write_b128 v5, v[46:49] offset:1024
    ds_write_b128 v5, v[50:53] offset:2048
    ds_write_b128 v5, v[54:57] offset:3072
    ds_write_b128 v5, v[58:61] offset:4096
    ds_write_b128 v5, v[62:65] offset:5120
    ds_write_b128 v5, v[66:69] offset:6144
    ds_write_b128 v5, v[70:73] offset:7168
    s_waitcnt lgkmcnt(0)
    s_barrier
    ds_read_b128 v[74:77], v1 offset:0
    ds_read_b128 v[78:81], v1 offset:8192
    ds_read_b128 v[82:85], v1 offset:16384
    ds_read_b128 v[86:89], v1 offset:24576
    ds_read_b128 v[90:93], v1 offset:1024
    ds_read_b128 v[94:97], v1 offset:9216
    ds_read_b128 v[98:101], v1 offset:17408
    ds_read_b128 v[102:105], v1 offset:25600
    s_lshl_b32 s17, s17, 3
    s_lshr_b32 s19, s19, s17
    s_lshl_b32 s19, s19, 16
    s_waitcnt vmcnt(0)
    v_lshlrev_b32 v10, 16, v138
    v_and_b32 v11, 0xffff0000, v138
    v_lshlrev_b32 v21, 16, v142
    v_and_b32 v20, 0xffff0000, v142
    v_lshlrev_b32 v12, 16, v139
    v_and_b32 v13, 0xffff0000, v139
    v_lshlrev_b32 v19, 16, v143
    v_and_b32 v18, 0xffff0000, v143
    v_lshlrev_b32 v14, 16, v140
    v_and_b32 v15, 0xffff0000, v140
    v_lshlrev_b32 v25, 16, v144
    v_and_b32 v24, 0xffff0000, v144
    v_lshlrev_b32 v16, 16, v141
    v_and_b32 v17, 0xffff0000, v141
    v_lshlrev_b32 v23, 16, v145
    v_and_b32 v22, 0xffff0000, v145
    s_mov_b32 s18, s19
    v_pk_add_f32 v[26:27], v[10:11], v[146:147] neg_lo:[0,1] neg_hi:[0,1]
    v_pk_add_f32 v[28:29], v[12:13], v[148:149] neg_lo:[0,1] neg_hi:[0,1]
    v_pk_add_f32 v[30:31], v[14:15], v[150:151] neg_lo:[0,1] neg_hi:[0,1]
    v_pk_add_f32 v[32:33], v[16:17], v[152:153] neg_lo:[0,1] neg_hi:[0,1]
    v_pk_mul_f32 v[26:27], v[26:27], v[158:159]
    v_pk_mul_f32 v[28:29], v[28:29], v[160:161]
    v_pk_mul_f32 v[30:31], v[30:31], v[162:163]
    v_pk_mul_f32 v[32:33], v[32:33], v[164:165]
    s_waitcnt lgkmcnt(0)
    v_pk_add_f32 v[74:75], v[74:75], v[78:79]
    v_pk_add_f32 v[82:83], v[82:83], v[86:87]
    v_pk_add_f32 v[76:77], v[76:77], v[80:81]
    v_pk_add_f32 v[84:85], v[84:85], v[88:89]
    v_pk_add_f32 v[74:75], v[74:75], v[82:83]
    v_pk_add_f32 v[76:77], v[76:77], v[84:85]
    v_pk_add_f32 v[90:91], v[90:91], v[94:95]
    v_pk_add_f32 v[98:99], v[98:99], v[102:103]
    v_pk_add_f32 v[92:93], v[92:93], v[96:97]
    v_pk_add_f32 v[100:101], v[100:101], v[104:105]
    v_pk_add_f32 v[90:91], v[90:91], v[98:99]
    v_pk_add_f32 v[92:93], v[92:93], v[100:101]
    v_pk_fma_f32 v[18:19], v[18:19], s[18:19], v[74:75]
    v_pk_fma_f32 v[20:21], v[20:21], s[18:19], v[76:77]
    v_pk_fma_f32 v[22:23], v[22:23], s[18:19], v[90:91]
    v_pk_fma_f32 v[24:25], v[24:25], s[18:19], v[92:93]
    v_pk_fma_f32 v[18:19], v[18:19], v[26:27], v[10:11]
    v_pk_fma_f32 v[20:21], v[20:21], v[28:29], v[12:13]
    v_pk_fma_f32 v[22:23], v[22:23], v[30:31], v[14:15]
    v_pk_fma_f32 v[24:25], v[24:25], v[32:33], v[16:17]
    v_cvt_pk_bf16_f32 v26, v18, v19
    v_cvt_pk_bf16_f32 v27, v20, v21
    v_cvt_pk_bf16_f32 v28, v22, v23
    v_cvt_pk_bf16_f32 v29, v24, v25
    buffer_store_dwordx2 v[26:27], v154, s[28:31], s33 offen
    buffer_store_dwordx2 v[28:29], v154, s[28:31], s33 offen offset:512
    s_endpgm
L_k1_cs:
    s_cmp_lt_u32 s2, 60
    s_cbranch_scc1 L_k1_pk
    v_readfirstlane_b32 s18, v2
    s_sub_u32 s14, s2, 60
    s_lshl_b32 s14, s14, 2
    s_add_u32 s14, s14, s18
    s_mul_i32 s15, s14, 43691
    s_lshr_b32 s15, s15, 19
    s_mul_i32 s16, s15, 12
    s_sub_u32 s16, s14, s16
    s_mul_i32 s17, s15, 240
    s_add_u32 s17, s17, s16
    s_lshl_b32 s17, s17, 10
    s_add_u32 s17, s17, 18874368
    v_lshlrev_b32 v3, 4, v1
    s_mov_b32 s40, 0x3f803f80
    v_mov_b32 v4, 0
    s_waitcnt lgkmcnt(0)
    s_mov_b32 s28, s12
    s_mov_b32 s29, s13
    s_mov_b32 s30, 23068672
    s_mov_b32 s31, 0x00020000
    buffer_load_dwordx4 v[8:11], v3, s[28:31], s17 offen
    s_add_u32 s17, s17, 12288
    buffer_load_dwordx4 v[12:15], v3, s[28:31], s17 offen
    s_add_u32 s17, s17, 12288
    buffer_load_dwordx4 v[16:19], v3, s[28:31], s17 offen
    s_add_u32 s17, s17, 12288
    buffer_load_dwordx4 v[20:23], v3, s[28:31], s17 offen
    s_add_u32 s17, s17, 12288
    buffer_load_dwordx4 v[24:27], v3, s[28:31], s17 offen
    s_add_u32 s17, s17, 12288
    buffer_load_dwordx4 v[28:31], v3, s[28:31], s17 offen
    s_add_u32 s17, s17, 12288
    buffer_load_dwordx4 v[32:35], v3, s[28:31], s17 offen
    s_add_u32 s17, s17, 12288
    buffer_load_dwordx4 v[36:39], v3, s[28:31], s17 offen
    s_add_u32 s17, s17, 12288
    buffer_load_dwordx4 v[40:43], v3, s[28:31], s17 offen
    s_add_u32 s17, s17, 12288
    buffer_load_dwordx4 v[44:47], v3, s[28:31], s17 offen
    s_add_u32 s17, s17, 12288
    buffer_load_dwordx4 v[48:51], v3, s[28:31], s17 offen
    s_add_u32 s17, s17, 12288
    buffer_load_dwordx4 v[52:55], v3, s[28:31], s17 offen
    s_add_u32 s17, s17, 12288
    buffer_load_dwordx4 v[56:59], v3, s[28:31], s17 offen
    s_add_u32 s17, s17, 12288
    buffer_load_dwordx4 v[60:63], v3, s[28:31], s17 offen
    s_add_u32 s17, s17, 12288
    buffer_load_dwordx4 v[64:67], v3, s[28:31], s17 offen
    s_add_u32 s17, s17, 12288
    buffer_load_dwordx4 v[68:71], v3, s[28:31], s17 offen
    s_add_u32 s17, s17, 12288
    buffer_load_dwordx4 v[72:75], v3, s[28:31], s17 offen
    s_add_u32 s17, s17, 12288
    buffer_load_dwordx4 v[76:79], v3, s[28:31], s17 offen
    s_add_u32 s17, s17, 12288
    buffer_load_dwordx4 v[80:83], v3, s[28:31], s17 offen
    s_add_u32 s17, s17, 12288
    buffer_load_dwordx4 v[84:87], v3, s[28:31], s17 offen
    s_add_u32 s17, s17, 12288
    s_cmp_ge_u32 s16, 6
    s_cselect_b32 s19, 5760, 0
    s_mul_i32 s15, s15, 384
    s_lshl_b32 s16, s16, 6
    s_add_u32 s15, s15, s16
    s_add_u32 s15, s15, s19
    s_add_u32 s15, s15, 7880704
    v_and_b32 v3, 15, v1
    v_lshlrev_b32 v3, 2, v3
    s_waitcnt vmcnt(19)
    v_dot2_f32_bf16 v4, v8, s40, v4
    v_dot2_f32_bf16 v4, v9, s40, v4
    v_dot2_f32_bf16 v4, v10, s40, v4
    v_dot2_f32_bf16 v4, v11, s40, v4
    s_waitcnt vmcnt(18)
    v_dot2_f32_bf16 v4, v12, s40, v4
    v_dot2_f32_bf16 v4, v13, s40, v4
    v_dot2_f32_bf16 v4, v14, s40, v4
    v_dot2_f32_bf16 v4, v15, s40, v4
    s_waitcnt vmcnt(17)
    v_dot2_f32_bf16 v4, v16, s40, v4
    v_dot2_f32_bf16 v4, v17, s40, v4
    v_dot2_f32_bf16 v4, v18, s40, v4
    v_dot2_f32_bf16 v4, v19, s40, v4
    s_waitcnt vmcnt(16)
    v_dot2_f32_bf16 v4, v20, s40, v4
    v_dot2_f32_bf16 v4, v21, s40, v4
    v_dot2_f32_bf16 v4, v22, s40, v4
    v_dot2_f32_bf16 v4, v23, s40, v4
    s_waitcnt vmcnt(15)
    v_dot2_f32_bf16 v4, v24, s40, v4
    v_dot2_f32_bf16 v4, v25, s40, v4
    v_dot2_f32_bf16 v4, v26, s40, v4
    v_dot2_f32_bf16 v4, v27, s40, v4
    s_waitcnt vmcnt(14)
    v_dot2_f32_bf16 v4, v28, s40, v4
    v_dot2_f32_bf16 v4, v29, s40, v4
    v_dot2_f32_bf16 v4, v30, s40, v4
    v_dot2_f32_bf16 v4, v31, s40, v4
    s_waitcnt vmcnt(13)
    v_dot2_f32_bf16 v4, v32, s40, v4
    v_dot2_f32_bf16 v4, v33, s40, v4
    v_dot2_f32_bf16 v4, v34, s40, v4
    v_dot2_f32_bf16 v4, v35, s40, v4
    s_waitcnt vmcnt(12)
    v_dot2_f32_bf16 v4, v36, s40, v4
    v_dot2_f32_bf16 v4, v37, s40, v4
    v_dot2_f32_bf16 v4, v38, s40, v4
    v_dot2_f32_bf16 v4, v39, s40, v4
    s_waitcnt vmcnt(11)
    v_dot2_f32_bf16 v4, v40, s40, v4
    v_dot2_f32_bf16 v4, v41, s40, v4
    v_dot2_f32_bf16 v4, v42, s40, v4
    v_dot2_f32_bf16 v4, v43, s40, v4
    s_waitcnt vmcnt(10)
    v_dot2_f32_bf16 v4, v44, s40, v4
    v_dot2_f32_bf16 v4, v45, s40, v4
    v_dot2_f32_bf16 v4, v46, s40, v4
    v_dot2_f32_bf16 v4, v47, s40, v4
    s_waitcnt vmcnt(9)
    v_dot2_f32_bf16 v4, v48, s40, v4
    v_dot2_f32_bf16 v4, v49, s40, v4
    v_dot2_f32_bf16 v4, v50, s40, v4
    v_dot2_f32_bf16 v4, v51, s40, v4
    s_waitcnt vmcnt(8)
    v_dot2_f32_bf16 v4, v52, s40, v4
    v_dot2_f32_bf16 v4, v53, s40, v4
    v_dot2_f32_bf16 v4, v54, s40, v4
    v_dot2_f32_bf16 v4, v55, s40, v4
    s_waitcnt vmcnt(7)
    v_dot2_f32_bf16 v4, v56, s40, v4
    v_dot2_f32_bf16 v4, v57, s40, v4
    v_dot2_f32_bf16 v4, v58, s40, v4
    v_dot2_f32_bf16 v4, v59, s40, v4
    s_waitcnt vmcnt(6)
    v_dot2_f32_bf16 v4, v60, s40, v4
    v_dot2_f32_bf16 v4, v61, s40, v4
    v_dot2_f32_bf16 v4, v62, s40, v4
    v_dot2_f32_bf16 v4, v63, s40, v4
    s_waitcnt vmcnt(5)
    v_dot2_f32_bf16 v4, v64, s40, v4
    v_dot2_f32_bf16 v4, v65, s40, v4
    v_dot2_f32_bf16 v4, v66, s40, v4
    v_dot2_f32_bf16 v4, v67, s40, v4
    s_waitcnt vmcnt(4)
    v_dot2_f32_bf16 v4, v68, s40, v4
    v_dot2_f32_bf16 v4, v69, s40, v4
    v_dot2_f32_bf16 v4, v70, s40, v4
    v_dot2_f32_bf16 v4, v71, s40, v4
    s_waitcnt vmcnt(3)
    v_dot2_f32_bf16 v4, v72, s40, v4
    v_dot2_f32_bf16 v4, v73, s40, v4
    v_dot2_f32_bf16 v4, v74, s40, v4
    v_dot2_f32_bf16 v4, v75, s40, v4
    s_waitcnt vmcnt(2)
    v_dot2_f32_bf16 v4, v76, s40, v4
    v_dot2_f32_bf16 v4, v77, s40, v4
    v_dot2_f32_bf16 v4, v78, s40, v4
    v_dot2_f32_bf16 v4, v79, s40, v4
    s_waitcnt vmcnt(1)
    v_dot2_f32_bf16 v4, v80, s40, v4
    v_dot2_f32_bf16 v4, v81, s40, v4
    v_dot2_f32_bf16 v4, v82, s40, v4
    v_dot2_f32_bf16 v4, v83, s40, v4
    s_waitcnt vmcnt(0)
    v_dot2_f32_bf16 v4, v84, s40, v4
    v_dot2_f32_bf16 v4, v85, s40, v4
    v_dot2_f32_bf16 v4, v86, s40, v4
    v_dot2_f32_bf16 v4, v87, s40, v4
    s_nop 2
    v_mov_b32 v5, v4
    s_nop 1
    v_permlane32_swap_b32 v4, v5
    s_nop 1
    v_add_f32 v4, v4, v5
    v_mov_b32 v5, v4
    s_nop 1
    v_permlane16_swap_b32 v4, v5
    s_nop 1
    v_add_f32 v4, v4, v5
    buffer_store_dword v4, v3, s[28:31], s15 offen
    s_endpgm
L_k1_pk:
    s_lshl_b32 s15, s2, 8
    s_mov_b32 s16, 0
    s_waitcnt lgkmcnt(0)
    s_mov_b32 s20, s8
    s_mov_b32 s21, s9
    s_mov_b32 s22, 1966080
    s_mov_b32 s23, 0x00020000
    s_add_u32 s36, s12, 16777216
    s_addc_u32 s37, s13, 0
    s_mov_b32 s38, 2097152
    s_mov_b32 s39, 0x00020000
    v_add_u32 v1, s15, v0
    v_mul_u32_u24 v2, 52429, v1
    v_lshrrev_b32 v2, 22, v2
    v_mul_u32_u24 v3, 80, v2
    v_sub_u32 v1, v1, v3
    v_lshrrev_b32 v3, 2, v2
    v_and_b32 v2, 3, v2
    v_lshlrev_b32 v4, 3, v3
    v_add_u32 v4, v4, v2
    v_mul_u32_u24 v4, 5120, v4
    v_lshl_add_u32 v4, v1, 4, v4
    s_movk_i32 s60, 1280
    s_movk_i32 s61, 2560
    s_movk_i32 s62, 3840
    v_add_u32 v5, 20480, v4
    buffer_load_dwordx4 v[10:13], v4, s[20:23], 0 offen
    buffer_load_dwordx4 v[14:17], v4, s[20:23], s60 offen
    buffer_load_dwordx4 v[18:21], v4, s[20:23], s61 offen
    buffer_load_dwordx4 v[22:25], v4, s[20:23], s62 offen
    buffer_load_dwordx4 v[26:29], v5, s[20:23], 0 offen
    buffer_load_dwordx4 v[30:33], v5, s[20:23], s60 offen
    buffer_load_dwordx4 v[34:37], v5, s[20:23], s61 offen
    buffer_load_dwordx4 v[38:41], v5, s[20:23], s62 offen
    v_lshrrev_b32 v6, 1, v1
    v_mul_u32_u24 v7, 13108, v6
    v_lshrrev_b32 v7, 16, v7
    v_mul_u32_u24 v8, 5, v7
    v_sub_u32 v6, v6, v8
    v_mad_u32_u24 v7, v7, 48, v3
    v_mad_u32_u24 v7, v7, 5, v6
    v_lshlrev_b32 v7, 10, v7
    v_lshl_add_u32 v7, v2, 8, v7
    v_and_b32 v1, 1, v1
    v_lshl_add_u32 v7, v1, 7, v7
    s_mov_b32 s60, 0x05040100
    s_mov_b32 s61, 0x07060302
    v_lshrrev_b32 v1, 6, v0
    v_mul_u32_u24 v1, 8448, v1
    v_and_b32 v2, 63, v0
    v_and_b32 v3, 7, v0
    v_bfe_u32 v4, v0, 3, 3
    v_lshl_add_u32 v5, v2, 2, v1
    ds_write_b32 v5, v7 offset:8192
    v_lshl_add_u32 v5, v4, 2, v1
    v_xor_b32 v6, v3, v4
    v_lshl_add_u32 v6, v6, 4, v1
    v_lshl_add_u32 v6, v4, 7, v6
    v_lshl_add_u32 v1, v2, 7, v1
    v_lshlrev_b32 v3, 4, v3
    v_add_u32 v1, v1, v3
    s_waitcnt lgkmcnt(0)
    ds_read_b32 v80, v5 offset:8192
    ds_read_b32 v81, v5 offset:8224
    ds_read_b32 v82, v5 offset:8256
    ds_read_b32 v83, v5 offset:8288
    ds_read_b32 v84, v5 offset:8320
    ds_read_b32 v85, v5 offset:8352
    ds_read_b32 v86, v5 offset:8384
    ds_read_b32 v87, v5 offset:8416
    s_waitcnt vmcnt(0)
    v_perm_b32 v42, v14, v10, s60
    v_perm_b32 v43, v22, v18, s60
    v_perm_b32 v44, v30, v26, s60
    v_perm_b32 v45, v38, v34, s60
    v_xor_b32 v2, 0, v1
    ds_write_b128 v2, v[42:45]
    v_perm_b32 v46, v14, v10, s61
    v_perm_b32 v47, v22, v18, s61
    v_perm_b32 v48, v30, v26, s61
    v_perm_b32 v49, v38, v34, s61
    v_xor_b32 v2, 16, v1
    ds_write_b128 v2, v[46:49]
    v_perm_b32 v50, v15, v11, s60
    v_perm_b32 v51, v23, v19, s60
    v_perm_b32 v52, v31, v27, s60
    v_perm_b32 v53, v39, v35, s60
    v_xor_b32 v2, 32, v1
    ds_write_b128 v2, v[50:53]
    v_perm_b32 v54, v15, v11, s61
    v_perm_b32 v55, v23, v19, s61
    v_perm_b32 v56, v31, v27, s61
    v_perm_b32 v57, v39, v35, s61
    v_xor_b32 v2, 48, v1
    ds_write_b128 v2, v[54:57]
    v_perm_b32 v58, v16, v12, s60
    v_perm_b32 v59, v24, v20, s60
    v_perm_b32 v60, v32, v28, s60
    v_perm_b32 v61, v40, v36, s60
    v_xor_b32 v2, 64, v1
    ds_write_b128 v2, v[58:61]
    v_perm_b32 v62, v16, v12, s61
    v_perm_b32 v63, v24, v20, s61
    v_perm_b32 v64, v32, v28, s61
    v_perm_b32 v65, v40, v36, s61
    v_xor_b32 v2, 80, v1
    ds_write_b128 v2, v[62:65]
    v_perm_b32 v66, v17, v13, s60
    v_perm_b32 v67, v25, v21, s60
    v_perm_b32 v68, v33, v29, s60
    v_perm_b32 v69, v41, v37, s60
    v_xor_b32 v2, 96, v1
    ds_write_b128 v2, v[66:69]
    v_perm_b32 v70, v17, v13, s61
    v_perm_b32 v71, v25, v21, s61
    v_perm_b32 v72, v33, v29, s61
    v_perm_b32 v73, v41, v37, s61
    v_xor_b32 v2, 112, v1
    ds_write_b128 v2, v[70:73]
    s_waitcnt lgkmcnt(0)
    ds_read_b128 v[10:13], v6 offset:0
    v_add_u32 v80, v80, v3
    ds_read_b128 v[14:17], v6 offset:1024
    v_add_u32 v81, v81, v3
    ds_read_b128 v[18:21], v6 offset:2048
    v_add_u32 v82, v82, v3
    ds_read_b128 v[22:25], v6 offset:3072
    v_add_u32 v83, v83, v3
    ds_read_b128 v[26:29], v6 offset:4096
    v_add_u32 v84, v84, v3
    ds_read_b128 v[30:33], v6 offset:5120
    v_add_u32 v85, v85, v3
    ds_read_b128 v[34:37], v6 offset:6144
    v_add_u32 v86, v86, v3
    ds_read_b128 v[38:41], v6 offset:7168
    v_add_u32 v87, v87, v3
    s_waitcnt lgkmcnt(7)
    buffer_store_dwordx4 v[10:13], v80, s[36:39], s16 offen
    s_waitcnt lgkmcnt(6)
    buffer_store_dwordx4 v[14:17], v81, s[36:39], s16 offen
    s_waitcnt lgkmcnt(5)
    buffer_store_dwordx4 v[18:21], v82, s[36:39], s16 offen
    s_waitcnt lgkmcnt(4)
    buffer_store_dwordx4 v[22:25], v83, s[36:39], s16 offen
    s_waitcnt lgkmcnt(3)
    buffer_store_dwordx4 v[26:29], v84, s[36:39], s16 offen
    s_waitcnt lgkmcnt(2)
    buffer_store_dwordx4 v[30:33], v85, s[36:39], s16 offen
    s_waitcnt lgkmcnt(1)
    buffer_store_dwordx4 v[34:37], v86, s[36:39], s16 offen
    s_waitcnt lgkmcnt(0)
    buffer_store_dwordx4 v[38:41], v87, s[36:39], s16 offen
    s_endpgm
L_k1_end:
    s_endpgm
.p2align 8
.globl k2_kernel
.type k2_kernel,@function
k2_kernel:
    s_cmp_ge_u32 s2, 256
    s_cbranch_scc1 L_k2_end
    s_load_dwordx2 s[12:13], s[0:1], 96
    s_and_b32 s14, s2, 7
    s_lshr_b32 s15, s2, 3
    s_and_b32 s16, s14, 1
    s_lshl_b32 s16, s16, 3
    s_and_b32 s17, s15, 7
    s_add_u32 s16, s16, s17
    s_lshr_b32 s17, s14, 1
    s_lshl_b32 s17, s17, 2
    s_lshr_b32 s15, s15, 3
    s_add_u32 s17, s17, s15
    v_lshrrev_b32 v2, 6, v0
    v_and_b32 v1, 63, v0
    s_nop 0
    v_readfirstlane_b32 s18, v2
    s_cmp_ge_u32 s18, 4
    s_cbranch_scc1 L_k2_ld
    s_and_b32 s19, s18, 1
    s_lshr_b32 s20, s18, 1
    v_lshrrev_b32 v3, 2, v1
    v_and_b32 v4, 3, v1
    v_lshlrev_b32 v4, 3, v4
    v_lshl_add_u32 v5, v3, 8, v4
    v_and_b32 v6, 7, v3
    v_lshlrev_b32 v7, 4, v1
    s_lshl_b32 s21, s19, 2
    s_lshl_b32 s22, s20, 2
    s_add_u32 s23, s22, 1
    s_add_u32 s24, s20, 2
    s_lshl_b32 s25, s20, 1
    s_add_u32 s36, s25, 0
    s_and_b32 s36, s36, 3
    s_add_u32 s36, s36, s21
    v_xor_b32 v9, s36, v6
    v_lshl_add_u32 v10, v9, 5, v5
    v_add_u32 v14, 61440, v10
    v_add_u32 v18, 122880, v10
    s_add_u32 s37, s25, 1
    s_and_b32 s37, s37, 3
    s_add_u32 s37, s37, s21
    v_xor_b32 v9, s37, v6
    v_lshl_add_u32 v11, v9, 5, v5
    v_add_u32 v15, 61440, v11
    v_add_u32 v19, 122880, v11
    s_add_u32 s38, s25, 2
    s_and_b32 s38, s38, 3
    s_add_u32 s38, s38, s21
    v_xor_b32 v9, s38, v6
    v_lshl_add_u32 v12, v9, 5, v5
    v_add_u32 v16, 61440, v12
    v_add_u32 v20, 122880, v12
    s_add_u32 s39, s25, 3
    s_and_b32 s39, s39, 3
    s_add_u32 s39, s39, s21
    v_xor_b32 v9, s39, v6
    v_lshl_add_u32 v13, v9, 5, v5
    v_add_u32 v17, 61440, v13
    v_add_u32 v21, 122880, v13
    s_lshl_b32 s25, s22, 10
    s_add_u32 s25, s25, 8192
    v_add_u32 v22, s25, v7
    v_add_u32 v24, 61440, v22
    v_add_u32 v26, 122880, v22
    s_lshl_b32 s25, s24, 10
    s_add_u32 s25, s25, 8192
    v_add_u32 v23, s25, v7
    v_add_u32 v25, 61440, v23
    v_add_u32 v27, 122880, v23
    v_lshrrev_b32 v3, 4, v1
    v_lshlrev_b32 v3, 4, v3
    s_mul_i32 s25, s17, 384
    s_add_u32 s25, s25, 7880704
    s_mov_b32 s40, 0x3f803f80
    v_mov_b32 v28, 0
    v_mov_b32 v29, 0
    v_mov_b32 v30, 0
    v_mov_b32 v31, 0
    s_waitcnt lgkmcnt(0)
    s_mov_b32 s28, s12
    s_mov_b32 s29, s13
    s_mov_b32 s30, 16777216
    s_mov_b32 s31, 0x00020000
    s_lshl_b32 s26, s22, 6
    s_add_u32 s26, s26, s25
    s_add_u32 s27, s26, 6144
    buffer_load_dwordx4 v[32:35], v3, s[28:31], s26 offen
    buffer_load_dwordx4 v[36:39], v3, s[28:31], s27 offen
    s_lshl_b32 s26, s23, 6
    s_add_u32 s26, s26, s25
    s_add_u32 s27, s26, 6144
    buffer_load_dwordx4 v[40:43], v3, s[28:31], s26 offen
    buffer_load_dwordx4 v[44:47], v3, s[28:31], s27 offen
    s_lshl_b32 s26, s24, 6
    s_add_u32 s26, s26, s25
    s_add_u32 s27, s26, 6144
    buffer_load_dwordx4 v[48:51], v3, s[28:31], s26 offen
    buffer_load_dwordx4 v[52:55], v3, s[28:31], s27 offen
    v_mov_b32 v248, s40
    v_mov_b32 v249, s40
    v_mov_b32 v250, s40
    v_mov_b32 v251, s40
    s_setprio 2
    s_barrier
    ds_read_b64_tr_b16 v[152:153], v10 offset:0
    ds_read_b64_tr_b16 v[154:155], v10 offset:4096
    ds_read_b64_tr_b16 v[156:157], v11 offset:0
    ds_read_b64_tr_b16 v[158:159], v11 offset:4096
    ds_read_b64_tr_b16 v[160:161], v12 offset:0
    ds_read_b64_tr_b16 v[162:163], v12 offset:4096
    ds_read_b64_tr_b16 v[164:165], v13 offset:0
    ds_read_b64_tr_b16 v[166:167], v13 offset:4096
    ds_read_b128 v[168:171], v22 offset:0
    ds_read_b128 v[180:183], v22 offset:6144
    ds_read_b128 v[172:175], v22 offset:1024
    ds_read_b128 v[184:187], v22 offset:7168
    ds_read_b128 v[176:179], v23 offset:0
    ds_read_b128 v[188:191], v23 offset:6144
    s_waitcnt lgkmcnt(0)
    s_barrier
    v_mfma_f32_16x16x32_bf16 v[56:59], v[168:171], v[152:155], 0
    ds_read_b64_tr_b16 v[192:193], v10 offset:20480
    v_mfma_f32_16x16x32_bf16 v[60:63], v[180:183], v[152:155], 0
    ds_read_b64_tr_b16 v[194:195], v10 offset:24576
    v_mfma_f32_16x16x32_bf16 v[64:67], v[172:175], v[152:155], 0
    ds_read_b64_tr_b16 v[196:197], v11 offset:20480
    v_mfma_f32_16x16x32_bf16 v[68:71], v[184:187], v[152:155], 0
    ds_read_b64_tr_b16 v[198:199], v11 offset:24576
    v_mfma_f32_16x16x32_bf16 v[72:75], v[176:179], v[152:155], 0
    ds_read_b64_tr_b16 v[200:201], v12 offset:20480
    v_mfma_f32_16x16x32_bf16 v[76:79], v[188:191], v[152:155], 0
    ds_read_b64_tr_b16 v[202:203], v12 offset:24576
    v_mfma_f32_16x16x32_bf16 v[80:83], v[168:171], v[156:159], 0
    ds_read_b64_tr_b16 v[204:205], v13 offset:20480
    v_mfma_f32_16x16x32_bf16 v[84:87], v[180:183], v[156:159], 0
    ds_read_b64_tr_b16 v[206:207], v13 offset:24576
    v_mfma_f32_16x16x32_bf16 v[88:91], v[172:175], v[156:159], 0
    ds_read_b128 v[208:211], v22 offset:20480
    v_mfma_f32_16x16x32_bf16 v[92:95], v[184:187], v[156:159], 0
    ds_read_b128 v[220:223], v22 offset:26624
    v_mfma_f32_16x16x32_bf16 v[96:99], v[176:179], v[156:159], 0
    ds_read_b128 v[212:215], v22 offset:21504
    v_mfma_f32_16x16x32_bf16 v[100:103], v[188:191], v[156:159], 0
    ds_read_b128 v[224:227], v22 offset:27648
    v_mfma_f32_16x16x32_bf16 v[104:107], v[168:171], v[160:163], 0
    ds_read_b128 v[216:219], v23 offset:20480
    v_mfma_f32_16x16x32_bf16 v[108:111], v[180:183], v[160:163], 0
    ds_read_b128 v[228:231], v23 offset:26624
    v_mfma_f32_16x16x32_bf16 v[112:115], v[172:175], v[160:163], 0
    v_mfma_f32_16x16x32_bf16 v[232:235], v[248:251], v[152:155], 0
    v_mfma_f32_16x16x32_bf16 v[116:119], v[184:187], v[160:163], 0
    v_mfma_f32_16x16x32_bf16 v[236:239], v[152:155], v[152:155], 0
    v_mfma_f32_16x16x32_bf16 v[120:123], v[176:179], v[160:163], 0
    v_mfma_f32_16x16x32_bf16 v[240:243], v[248:251], v[156:159], 0
    v_mfma_f32_16x16x32_bf16 v[124:127], v[188:191], v[160:163], 0
    v_mfma_f32_16x16x32_bf16 v[244:247], v[156:159], v[156:159], 0
    v_mfma_f32_16x16x32_bf16 v[128:131], v[168:171], v[164:167], 0
    v_mfma_f32_16x16x32_bf16 v[132:135], v[180:183], v[164:167], 0
    v_mfma_f32_16x16x32_bf16 v[136:139], v[172:175], v[164:167], 0
    v_mfma_f32_16x16x32_bf16 v[140:143], v[184:187], v[164:167], 0
    v_mfma_f32_16x16x32_bf16 v[144:147], v[176:179], v[164:167], 0
    v_mfma_f32_16x16x32_bf16 v[148:151], v[188:191], v[164:167], 0
    s_waitcnt lgkmcnt(0)
    s_barrier
    v_mfma_f32_16x16x32_bf16 v[56:59], v[208:211], v[192:195], v[56:59]
    ds_read_b64_tr_b16 v[152:153], v10 offset:40960
    v_mfma_f32_16x16x32_bf16 v[60:63], v[220:223], v[192:195], v[60:63]
    ds_read_b64_tr_b16 v[154:155], v10 offset:45056
    v_mfma_f32_16x16x32_bf16 v[64:67], v[212:215], v[192:195], v[64:67]
    ds_read_b64_tr_b16 v[156:157], v11 offset:40960
    v_mfma_f32_16x16x32_bf16 v[68:71], v[224:227], v[192:195], v[68:71]
    ds_read_b64_tr_b16 v[158:159], v11 offset:45056
    v_mfma_f32_16x16x32_bf16 v[72:75], v[216:219], v[192:195], v[72:75]
    ds_read_b64_tr_b16 v[160:161], v12 offset:40960
    v_mfma_f32_16x16x32_bf16 v[76:79], v[228:231], v[192:195], v[76:79]
    ds_read_b64_tr_b16 v[162:163], v12 offset:45056
    v_mfma_f32_16x16x32_bf16 v[80:83], v[208:211], v[196:199], v[80:83]
    ds_read_b64_tr_b16 v[164:165], v13 offset:40960
    v_mfma_f32_16x16x32_bf16 v[84:87], v[220:223], v[196:199], v[84:87]
    ds_read_b64_tr_b16 v[166:167], v13 offset:45056
    v_mfma_f32_16x16x32_bf16 v[88:91], v[212:215], v[196:199], v[88:91]
    ds_read_b128 v[168:171], v22 offset:40960
    v_mfma_f32_16x16x32_bf16 v[92:95], v[224:227], v[196:199], v[92:95]
    ds_read_b128 v[180:183], v22 offset:47104
    v_mfma_f32_16x16x32_bf16 v[96:99], v[216:219], v[196:199], v[96:99]
    ds_read_b128 v[172:175], v22 offset:41984
    v_mfma_f32_16x16x32_bf16 v[100:103], v[228:231], v[196:199], v[100:103]
    ds_read_b128 v[184:187], v22 offset:48128
    v_mfma_f32_16x16x32_bf16 v[104:107], v[208:211], v[200:203], v[104:107]
    ds_read_b128 v[176:179], v23 offset:40960
    v_mfma_f32_16x16x32_bf16 v[108:111], v[220:223], v[200:203], v[108:111]
    ds_read_b128 v[188:191], v23 offset:47104
    v_mfma_f32_16x16x32_bf16 v[112:115], v[212:215], v[200:203], v[112:115]
    v_mfma_f32_16x16x32_bf16 v[232:235], v[248:251], v[192:195], v[232:235]
    v_mfma_f32_16x16x32_bf16 v[116:119], v[224:227], v[200:203], v[116:119]
    v_mfma_f32_16x16x32_bf16 v[236:239], v[192:195], v[192:195], v[236:239]
    v_mfma_f32_16x16x32_bf16 v[120:123], v[216:219], v[200:203], v[120:123]
    v_mfma_f32_16x16x32_bf16 v[240:243], v[248:251], v[196:199], v[240:243]
    v_mfma_f32_16x16x32_bf16 v[124:127], v[228:231], v[200:203], v[124:127]
    v_mfma_f32_16x16x32_bf16 v[244:247], v[196:199], v[196:199], v[244:247]
    v_mfma_f32_16x16x32_bf16 v[128:131], v[208:211], v[204:207], v[128:131]
    v_mfma_f32_16x16x32_bf16 v[132:135], v[220:223], v[204:207], v[132:135]
    v_mfma_f32_16x16x32_bf16 v[136:139], v[212:215], v[204:207], v[136:139]
    v_mfma_f32_16x16x32_bf16 v[140:143], v[224:227], v[204:207], v[140:143]
    v_mfma_f32_16x16x32_bf16 v[144:147], v[216:219], v[204:207], v[144:147]
    v_mfma_f32_16x16x32_bf16 v[148:151], v[228:231], v[204:207], v[148:151]
    s_waitcnt lgkmcnt(0)
    s_barrier
    v_mfma_f32_16x16x32_bf16 v[56:59], v[168:171], v[152:155], v[56:59]
    ds_read_b64_tr_b16 v[192:193], v14 offset:0
    v_mfma_f32_16x16x32_bf16 v[60:63], v[180:183], v[152:155], v[60:63]
    ds_read_b64_tr_b16 v[194:195], v14 offset:4096
    v_mfma_f32_16x16x32_bf16 v[64:67], v[172:175], v[152:155], v[64:67]
    ds_read_b64_tr_b16 v[196:197], v15 offset:0
    v_mfma_f32_16x16x32_bf16 v[68:71], v[184:187], v[152:155], v[68:71]
    ds_read_b64_tr_b16 v[198:199], v15 offset:4096
    v_mfma_f32_16x16x32_bf16 v[72:75], v[176:179], v[152:155], v[72:75]
    ds_read_b64_tr_b16 v[200:201], v16 offset:0
    v_mfma_f32_16x16x32_bf16 v[76:79], v[188:191], v[152:155], v[76:79]
    ds_read_b64_tr_b16 v[202:203], v16 offset:4096
    v_mfma_f32_16x16x32_bf16 v[80:83], v[168:171], v[156:159], v[80:83]
    ds_read_b64_tr_b16 v[204:205], v17 offset:0
    v_mfma_f32_16x16x32_bf16 v[84:87], v[180:183], v[156:159], v[84:87]
    ds_read_b64_tr_b16 v[206:207], v17 offset:4096
    v_mfma_f32_16x16x32_bf16 v[88:91], v[172:175], v[156:159], v[88:91]
    ds_read_b128 v[208:211], v24 offset:0
    v_mfma_f32_16x16x32_bf16 v[92:95], v[184:187], v[156:159], v[92:95]
    ds_read_b128 v[220:223], v24 offset:6144
    v_mfma_f32_16x16x32_bf16 v[96:99], v[176:179], v[156:159], v[96:99]
    ds_read_b128 v[212:215], v24 offset:1024
    v_mfma_f32_16x16x32_bf16 v[100:103], v[188:191], v[156:159], v[100:103]
    ds_read_b128 v[224:227], v24 offset:7168
    v_mfma_f32_16x16x32_bf16 v[104:107], v[168:171], v[160:163], v[104:107]
    ds_read_b128 v[216:219], v25 offset:0
    v_mfma_f32_16x16x32_bf16 v[108:111], v[180:183], v[160:163], v[108:111]
    ds_read_b128 v[228:231], v25 offset:6144
    v_mfma_f32_16x16x32_bf16 v[112:115], v[172:175], v[160:163], v[112:115]
    v_mfma_f32_16x16x32_bf16 v[232:235], v[248:251], v[152:155], v[232:235]
    v_mfma_f32_16x16x32_bf16 v[116:119], v[184:187], v[160:163], v[116:119]
    v_mfma_f32_16x16x32_bf16 v[236:239], v[152:155], v[152:155], v[236:239]
    v_mfma_f32_16x16x32_bf16 v[120:123], v[176:179], v[160:163], v[120:123]
    v_mfma_f32_16x16x32_bf16 v[240:243], v[248:251], v[156:159], v[240:243]
    v_mfma_f32_16x16x32_bf16 v[124:127], v[188:191], v[160:163], v[124:127]
    v_mfma_f32_16x16x32_bf16 v[244:247], v[156:159], v[156:159], v[244:247]
    v_mfma_f32_16x16x32_bf16 v[128:131], v[168:171], v[164:167], v[128:131]
    v_mfma_f32_16x16x32_bf16 v[132:135], v[180:183], v[164:167], v[132:135]
    v_mfma_f32_16x16x32_bf16 v[136:139], v[172:175], v[164:167], v[136:139]
    v_mfma_f32_16x16x32_bf16 v[140:143], v[184:187], v[164:167], v[140:143]
    v_mfma_f32_16x16x32_bf16 v[144:147], v[176:179], v[164:167], v[144:147]
    v_mfma_f32_16x16x32_bf16 v[148:151], v[188:191], v[164:167], v[148:151]
    s_waitcnt lgkmcnt(0)
    s_barrier
    v_mfma_f32_16x16x32_bf16 v[56:59], v[208:211], v[192:195], v[56:59]
    ds_read_b64_tr_b16 v[152:153], v14 offset:20480
    v_mfma_f32_16x16x32_bf16 v[60:63], v[220:223], v[192:195], v[60:63]
    ds_read_b64_tr_b16 v[154:155], v14 offset:24576
    v_mfma_f32_16x16x32_bf16 v[64:67], v[212:215], v[192:195], v[64:67]
    ds_read_b64_tr_b16 v[156:157], v15 offset:20480
    v_mfma_f32_16x16x32_bf16 v[68:71], v[224:227], v[192:195], v[68:71]
    ds_read_b64_tr_b16 v[158:159], v15 offset:24576
    v_mfma_f32_16x16x32_bf16 v[72:75], v[216:219], v[192:195], v[72:75]
    ds_read_b64_tr_b16 v[160:161], v16 offset:20480
    v_mfma_f32_16x16x32_bf16 v[76:79], v[228:231], v[192:195], v[76:79]
    ds_read_b64_tr_b16 v[162:163], v16 offset:24576
    v_mfma_f32_16x16x32_bf16 v[80:83], v[208:211], v[196:199], v[80:83]
    ds_read_b64_tr_b16 v[164:165], v17 offset:20480
    v_mfma_f32_16x16x32_bf16 v[84:87], v[220:223], v[196:199], v[84:87]
    ds_read_b64_tr_b16 v[166:167], v17 offset:24576
    v_mfma_f32_16x16x32_bf16 v[88:91], v[212:215], v[196:199], v[88:91]
    ds_read_b128 v[168:171], v24 offset:20480
    v_mfma_f32_16x16x32_bf16 v[92:95], v[224:227], v[196:199], v[92:95]
    ds_read_b128 v[180:183], v24 offset:26624
    v_mfma_f32_16x16x32_bf16 v[96:99], v[216:219], v[196:199], v[96:99]
    ds_read_b128 v[172:175], v24 offset:21504
    v_mfma_f32_16x16x32_bf16 v[100:103], v[228:231], v[196:199], v[100:103]
    ds_read_b128 v[184:187], v24 offset:27648
    v_mfma_f32_16x16x32_bf16 v[104:107], v[208:211], v[200:203], v[104:107]
    ds_read_b128 v[176:179], v25 offset:20480
    v_mfma_f32_16x16x32_bf16 v[108:111], v[220:223], v[200:203], v[108:111]
    ds_read_b128 v[188:191], v25 offset:26624
    v_mfma_f32_16x16x32_bf16 v[112:115], v[212:215], v[200:203], v[112:115]
    v_mfma_f32_16x16x32_bf16 v[232:235], v[248:251], v[192:195], v[232:235]
    v_mfma_f32_16x16x32_bf16 v[116:119], v[224:227], v[200:203], v[116:119]
    v_mfma_f32_16x16x32_bf16 v[236:239], v[192:195], v[192:195], v[236:239]
    v_mfma_f32_16x16x32_bf16 v[120:123], v[216:219], v[200:203], v[120:123]
    v_mfma_f32_16x16x32_bf16 v[240:243], v[248:251], v[196:199], v[240:243]
    v_mfma_f32_16x16x32_bf16 v[124:127], v[228:231], v[200:203], v[124:127]
    v_mfma_f32_16x16x32_bf16 v[244:247], v[196:199], v[196:199], v[244:247]
    v_mfma_f32_16x16x32_bf16 v[128:131], v[208:211], v[204:207], v[128:131]
    v_mfma_f32_16x16x32_bf16 v[132:135], v[220:223], v[204:207], v[132:135]
    v_mfma_f32_16x16x32_bf16 v[136:139], v[212:215], v[204:207], v[136:139]
    v_mfma_f32_16x16x32_bf16 v[140:143], v[224:227], v[204:207], v[140:143]
    v_mfma_f32_16x16x32_bf16 v[144:147], v[216:219], v[204:207], v[144:147]
    v_mfma_f32_16x16x32_bf16 v[148:151], v[228:231], v[204:207], v[148:151]
    s_waitcnt lgkmcnt(0)
    s_barrier
    v_mfma_f32_16x16x32_bf16 v[56:59], v[168:171], v[152:155], v[56:59]
    ds_read_b64_tr_b16 v[192:193], v14 offset:40960
    v_mfma_f32_16x16x32_bf16 v[60:63], v[180:183], v[152:155], v[60:63]
    ds_read_b64_tr_b16 v[194:195], v14 offset:45056
    v_mfma_f32_16x16x32_bf16 v[64:67], v[172:175], v[152:155], v[64:67]
    ds_read_b64_tr_b16 v[196:197], v15 offset:40960
    v_mfma_f32_16x16x32_bf16 v[68:71], v[184:187], v[152:155], v[68:71]
    ds_read_b64_tr_b16 v[198:199], v15 offset:45056
    v_mfma_f32_16x16x32_bf16 v[72:75], v[176:179], v[152:155], v[72:75]
    ds_read_b64_tr_b16 v[200:201], v16 offset:40960
    v_mfma_f32_16x16x32_bf16 v[76:79], v[188:191], v[152:155], v[76:79]
    ds_read_b64_tr_b16 v[202:203], v16 offset:45056
    v_mfma_f32_16x16x32_bf16 v[80:83], v[168:171], v[156:159], v[80:83]
    ds_read_b64_tr_b16 v[204:205], v17 offset:40960
    v_mfma_f32_16x16x32_bf16 v[84:87], v[180:183], v[156:159], v[84:87]
    ds_read_b64_tr_b16 v[206:207], v17 offset:45056
    v_mfma_f32_16x16x32_bf16 v[88:91], v[172:175], v[156:159], v[88:91]
    ds_read_b128 v[208:211], v24 offset:40960
    v_mfma_f32_16x16x32_bf16 v[92:95], v[184:187], v[156:159], v[92:95]
    ds_read_b128 v[220:223], v24 offset:47104
    v_mfma_f32_16x16x32_bf16 v[96:99], v[176:179], v[156:159], v[96:99]
    ds_read_b128 v[212:215], v24 offset:41984
    v_mfma_f32_16x16x32_bf16 v[100:103], v[188:191], v[156:159], v[100:103]
    ds_read_b128 v[224:227], v24 offset:48128
    v_mfma_f32_16x16x32_bf16 v[104:107], v[168:171], v[160:163], v[104:107]
    ds_read_b128 v[216:219], v25 offset:40960
    v_mfma_f32_16x16x32_bf16 v[108:111], v[180:183], v[160:163], v[108:111]
    ds_read_b128 v[228:231], v25 offset:47104
    v_mfma_f32_16x16x32_bf16 v[112:115], v[172:175], v[160:163], v[112:115]
    v_mfma_f32_16x16x32_bf16 v[232:235], v[248:251], v[152:155], v[232:235]
    v_mfma_f32_16x16x32_bf16 v[116:119], v[184:187], v[160:163], v[116:119]
    v_mfma_f32_16x16x32_bf16 v[236:239], v[152:155], v[152:155], v[236:239]
    v_mfma_f32_16x16x32_bf16 v[120:123], v[176:179], v[160:163], v[120:123]
    v_mfma_f32_16x16x32_bf16 v[240:243], v[248:251], v[156:159], v[240:243]
    v_mfma_f32_16x16x32_bf16 v[124:127], v[188:191], v[160:163], v[124:127]
    v_mfma_f32_16x16x32_bf16 v[244:247], v[156:159], v[156:159], v[244:247]
    v_mfma_f32_16x16x32_bf16 v[128:131], v[168:171], v[164:167], v[128:131]
    v_mfma_f32_16x16x32_bf16 v[132:135], v[180:183], v[164:167], v[132:135]
    v_mfma_f32_16x16x32_bf16 v[136:139], v[172:175], v[164:167], v[136:139]
    v_mfma_f32_16x16x32_bf16 v[140:143], v[184:187], v[164:167], v[140:143]
    v_mfma_f32_16x16x32_bf16 v[144:147], v[176:179], v[164:167], v[144:147]
    v_mfma_f32_16x16x32_bf16 v[148:151], v[188:191], v[164:167], v[148:151]
    s_waitcnt lgkmcnt(0)
    s_barrier
    v_mfma_f32_16x16x32_bf16 v[56:59], v[208:211], v[192:195], v[56:59]
    ds_read_b64_tr_b16 v[152:153], v18 offset:0
    v_mfma_f32_16x16x32_bf16 v[60:63], v[220:223], v[192:195], v[60:63]
    ds_read_b64_tr_b16 v[154:155], v18 offset:4096
    v_mfma_f32_16x16x32_bf16 v[64:67], v[212:215], v[192:195], v[64:67]
    ds_read_b64_tr_b16 v[156:157], v19 offset:0
    v_mfma_f32_16x16x32_bf16 v[68:71], v[224:227], v[192:195], v[68:71]
    ds_read_b64_tr_b16 v[158:159], v19 offset:4096
    v_mfma_f32_16x16x32_bf16 v[72:75], v[216:219], v[192:195], v[72:75]
    ds_read_b64_tr_b16 v[160:161], v20 offset:0
    v_mfma_f32_16x16x32_bf16 v[76:79], v[228:231], v[192:195], v[76:79]
    ds_read_b64_tr_b16 v[162:163], v20 offset:4096
    v_mfma_f32_16x16x32_bf16 v[80:83], v[208:211], v[196:199], v[80:83]
    ds_read_b64_tr_b16 v[164:165], v21 offset:0
    v_mfma_f32_16x16x32_bf16 v[84:87], v[220:223], v[196:199], v[84:87]
    ds_read_b64_tr_b16 v[166:167], v21 offset:4096
    v_mfma_f32_16x16x32_bf16 v[88:91], v[212:215], v[196:199], v[88:91]
    ds_read_b128 v[168:171], v26 offset:0
    v_mfma_f32_16x16x32_bf16 v[92:95], v[224:227], v[196:199], v[92:95]
    ds_read_b128 v[180:183], v26 offset:6144
    v_mfma_f32_16x16x32_bf16 v[96:99], v[216:219], v[196:199], v[96:99]
    ds_read_b128 v[172:175], v26 offset:1024
    v_mfma_f32_16x16x32_bf16 v[100:103], v[228:231], v[196:199], v[100:103]
    ds_read_b128 v[184:187], v26 offset:7168
    v_mfma_f32_16x16x32_bf16 v[104:107], v[208:211], v[200:203], v[104:107]
    ds_read_b128 v[176:179], v27 offset:0
    v_mfma_f32_16x16x32_bf16 v[108:111], v[220:223], v[200:203], v[108:111]
    ds_read_b128 v[188:191], v27 offset:6144
    v_mfma_f32_16x16x32_bf16 v[112:115], v[212:215], v[200:203], v[112:115]
    v_mfma_f32_16x16x32_bf16 v[232:235], v[248:251], v[192:195], v[232:235]
    v_mfma_f32_16x16x32_bf16 v[116:119], v[224:227], v[200:203], v[116:119]
    v_mfma_f32_16x16x32_bf16 v[236:239], v[192:195], v[192:195], v[236:239]
    v_mfma_f32_16x16x32_bf16 v[120:123], v[216:219], v[200:203], v[120:123]
    v_mfma_f32_16x16x32_bf16 v[240:243], v[248:251], v[196:199], v[240:243]
    v_mfma_f32_16x16x32_bf16 v[124:127], v[228:231], v[200:203], v[124:127]
    v_mfma_f32_16x16x32_bf16 v[244:247], v[196:199], v[196:199], v[244:247]
    v_mfma_f32_16x16x32_bf16 v[128:131], v[208:211], v[204:207], v[128:131]
    v_mfma_f32_16x16x32_bf16 v[132:135], v[220:223], v[204:207], v[132:135]
    v_mfma_f32_16x16x32_bf16 v[136:139], v[212:215], v[204:207], v[136:139]
    v_mfma_f32_16x16x32_bf16 v[140:143], v[224:227], v[204:207], v[140:143]
    v_mfma_f32_16x16x32_bf16 v[144:147], v[216:219], v[204:207], v[144:147]
    v_mfma_f32_16x16x32_bf16 v[148:151], v[228:231], v[204:207], v[148:151]
    s_waitcnt lgkmcnt(0)
    s_barrier
    v_mfma_f32_16x16x32_bf16 v[56:59], v[168:171], v[152:155], v[56:59]
    ds_read_b64_tr_b16 v[192:193], v10 offset:0
    v_mfma_f32_16x16x32_bf16 v[60:63], v[180:183], v[152:155], v[60:63]
    ds_read_b64_tr_b16 v[194:195], v10 offset:4096
    v_mfma_f32_16x16x32_bf16 v[64:67], v[172:175], v[152:155], v[64:67]
    ds_read_b64_tr_b16 v[196:197], v11 offset:0
    v_mfma_f32_16x16x32_bf16 v[68:71], v[184:187], v[152:155], v[68:71]
    ds_read_b64_tr_b16 v[198:199], v11 offset:4096
    v_mfma_f32_16x16x32_bf16 v[72:75], v[176:179], v[152:155], v[72:75]
    ds_read_b64_tr_b16 v[200:201], v12 offset:0
    v_mfma_f32_16x16x32_bf16 v[76:79], v[188:191], v[152:155], v[76:79]
    ds_read_b64_tr_b16 v[202:203], v12 offset:4096
    v_mfma_f32_16x16x32_bf16 v[80:83], v[168:171], v[156:159], v[80:83]
    ds_read_b64_tr_b16 v[204:205], v13 offset:0
    v_mfma_f32_16x16x32_bf16 v[84:87], v[180:183], v[156:159], v[84:87]
    ds_read_b64_tr_b16 v[206:207], v13 offset:4096
    v_mfma_f32_16x16x32_bf16 v[88:91], v[172:175], v[156:159], v[88:91]
    ds_read_b128 v[208:211], v22 offset:0
    v_mfma_f32_16x16x32_bf16 v[92:95], v[184:187], v[156:159], v[92:95]
    ds_read_b128 v[220:223], v22 offset:6144
    v_mfma_f32_16x16x32_bf16 v[96:99], v[176:179], v[156:159], v[96:99]
    ds_read_b128 v[212:215], v22 offset:1024
    v_mfma_f32_16x16x32_bf16 v[100:103], v[188:191], v[156:159], v[100:103]
    ds_read_b128 v[224:227], v22 offset:7168
    v_mfma_f32_16x16x32_bf16 v[104:107], v[168:171], v[160:163], v[104:107]
    ds_read_b128 v[216:219], v23 offset:0
    v_mfma_f32_16x16x32_bf16 v[108:111], v[180:183], v[160:163], v[108:111]
    ds_read_b128 v[228:231], v23 offset:6144
    v_mfma_f32_16x16x32_bf16 v[112:115], v[172:175], v[160:163], v[112:115]
    v_mfma_f32_16x16x32_bf16 v[232:235], v[248:251], v[152:155], v[232:235]
    v_mfma_f32_16x16x32_bf16 v[116:119], v[184:187], v[160:163], v[116:119]
    v_mfma_f32_16x16x32_bf16 v[236:239], v[152:155], v[152:155], v[236:239]
    v_mfma_f32_16x16x32_bf16 v[120:123], v[176:179], v[160:163], v[120:123]
    v_mfma_f32_16x16x32_bf16 v[240:243], v[248:251], v[156:159], v[240:243]
    v_mfma_f32_16x16x32_bf16 v[124:127], v[188:191], v[160:163], v[124:127]
    v_mfma_f32_16x16x32_bf16 v[244:247], v[156:159], v[156:159], v[244:247]
    v_mfma_f32_16x16x32_bf16 v[128:131], v[168:171], v[164:167], v[128:131]
    v_mfma_f32_16x16x32_bf16 v[132:135], v[180:183], v[164:167], v[132:135]
    v_mfma_f32_16x16x32_bf16 v[136:139], v[172:175], v[164:167], v[136:139]
    v_mfma_f32_16x16x32_bf16 v[140:143], v[184:187], v[164:167], v[140:143]
    v_mfma_f32_16x16x32_bf16 v[144:147], v[176:179], v[164:167], v[144:147]
    v_mfma_f32_16x16x32_bf16 v[148:151], v[188:191], v[164:167], v[148:151]
    s_waitcnt lgkmcnt(0)
    s_barrier
    v_mfma_f32_16x16x32_bf16 v[56:59], v[208:211], v[192:195], v[56:59]
    ds_read_b64_tr_b16 v[152:153], v10 offset:20480
    v_mfma_f32_16x16x32_bf16 v[60:63], v[220:223], v[192:195], v[60:63]
    ds_read_b64_tr_b16 v[154:155], v10 offset:24576
    v_mfma_f32_16x16x32_bf16 v[64:67], v[212:215], v[192:195], v[64:67]
    ds_read_b64_tr_b16 v[156:157], v11 offset:20480
    v_mfma_f32_16x16x32_bf16 v[68:71], v[224:227], v[192:195], v[68:71]
    ds_read_b64_tr_b16 v[158:159], v11 offset:24576
    v_mfma_f32_16x16x32_bf16 v[72:75], v[216:219], v[192:195], v[72:75]
    ds_read_b64_tr_b16 v[160:161], v12 offset:20480
    v_mfma_f32_16x16x32_bf16 v[76:79], v[228:231], v[192:195], v[76:79]
    ds_read_b64_tr_b16 v[162:163], v12 offset:24576
    v_mfma_f32_16x16x32_bf16 v[80:83], v[208:211], v[196:199], v[80:83]
    ds_read_b64_tr_b16 v[164:165], v13 offset:20480
    v_mfma_f32_16x16x32_bf16 v[84:87], v[220:223], v[196:199], v[84:87]
    ds_read_b64_tr_b16 v[166:167], v13 offset:24576
    v_mfma_f32_16x16x32_bf16 v[88:91], v[212:215], v[196:199], v[88:91]
    ds_read_b128 v[168:171], v22 offset:20480
    v_mfma_f32_16x16x32_bf16 v[92:95], v[224:227], v[196:199], v[92:95]
    ds_read_b128 v[180:183], v22 offset:26624
    v_mfma_f32_16x16x32_bf16 v[96:99], v[216:219], v[196:199], v[96:99]
    ds_read_b128 v[172:175], v22 offset:21504
    v_mfma_f32_16x16x32_bf16 v[100:103], v[228:231], v[196:199], v[100:103]
    ds_read_b128 v[184:187], v22 offset:27648
    v_mfma_f32_16x16x32_bf16 v[104:107], v[208:211], v[200:203], v[104:107]
    ds_read_b128 v[176:179], v23 offset:20480
    v_mfma_f32_16x16x32_bf16 v[108:111], v[220:223], v[200:203], v[108:111]
    ds_read_b128 v[188:191], v23 offset:26624
    v_mfma_f32_16x16x32_bf16 v[112:115], v[212:215], v[200:203], v[112:115]
    v_mfma_f32_16x16x32_bf16 v[232:235], v[248:251], v[192:195], v[232:235]
    v_mfma_f32_16x16x32_bf16 v[116:119], v[224:227], v[200:203], v[116:119]
    v_mfma_f32_16x16x32_bf16 v[236:239], v[192:195], v[192:195], v[236:239]
    v_mfma_f32_16x16x32_bf16 v[120:123], v[216:219], v[200:203], v[120:123]
    v_mfma_f32_16x16x32_bf16 v[240:243], v[248:251], v[196:199], v[240:243]
    v_mfma_f32_16x16x32_bf16 v[124:127], v[228:231], v[200:203], v[124:127]
    v_mfma_f32_16x16x32_bf16 v[244:247], v[196:199], v[196:199], v[244:247]
    v_mfma_f32_16x16x32_bf16 v[128:131], v[208:211], v[204:207], v[128:131]
    v_mfma_f32_16x16x32_bf16 v[132:135], v[220:223], v[204:207], v[132:135]
    v_mfma_f32_16x16x32_bf16 v[136:139], v[212:215], v[204:207], v[136:139]
    v_mfma_f32_16x16x32_bf16 v[140:143], v[224:227], v[204:207], v[140:143]
    v_mfma_f32_16x16x32_bf16 v[144:147], v[216:219], v[204:207], v[144:147]
    v_mfma_f32_16x16x32_bf16 v[148:151], v[228:231], v[204:207], v[148:151]
    s_waitcnt lgkmcnt(0)
    s_barrier
    v_mfma_f32_16x16x32_bf16 v[56:59], v[168:171], v[152:155], v[56:59]
    ds_read_b64_tr_b16 v[192:193], v10 offset:40960
    v_mfma_f32_16x16x32_bf16 v[60:63], v[180:183], v[152:155], v[60:63]
    ds_read_b64_tr_b16 v[194:195], v10 offset:45056
    v_mfma_f32_16x16x32_bf16 v[64:67], v[172:175], v[152:155], v[64:67]
    ds_read_b64_tr_b16 v[196:197], v11 offset:40960
    v_mfma_f32_16x16x32_bf16 v[68:71], v[184:187], v[152:155], v[68:71]
    ds_read_b64_tr_b16 v[198:199], v11 offset:45056
    v_mfma_f32_16x16x32_bf16 v[72:75], v[176:179], v[152:155], v[72:75]
    ds_read_b64_tr_b16 v[200:201], v12 offset:40960
    v_mfma_f32_16x16x32_bf16 v[76:79], v[188:191], v[152:155], v[76:79]
    ds_read_b64_tr_b16 v[202:203], v12 offset:45056
    v_mfma_f32_16x16x32_bf16 v[80:83], v[168:171], v[156:159], v[80:83]
    ds_read_b64_tr_b16 v[204:205], v13 offset:40960
    v_mfma_f32_16x16x32_bf16 v[84:87], v[180:183], v[156:159], v[84:87]
    ds_read_b64_tr_b16 v[206:207], v13 offset:45056
    v_mfma_f32_16x16x32_bf16 v[88:91], v[172:175], v[156:159], v[88:91]
    ds_read_b128 v[208:211], v22 offset:40960
    v_mfma_f32_16x16x32_bf16 v[92:95], v[184:187], v[156:159], v[92:95]
    ds_read_b128 v[220:223], v22 offset:47104
    v_mfma_f32_16x16x32_bf16 v[96:99], v[176:179], v[156:159], v[96:99]
    ds_read_b128 v[212:215], v22 offset:41984
    v_mfma_f32_16x16x32_bf16 v[100:103], v[188:191], v[156:159], v[100:103]
    ds_read_b128 v[224:227], v22 offset:48128
    v_mfma_f32_16x16x32_bf16 v[104:107], v[168:171], v[160:163], v[104:107]
    ds_read_b128 v[216:219], v23 offset:40960
    v_mfma_f32_16x16x32_bf16 v[108:111], v[180:183], v[160:163], v[108:111]
    ds_read_b128 v[228:231], v23 offset:47104
    v_mfma_f32_16x16x32_bf16 v[112:115], v[172:175], v[160:163], v[112:115]
    v_mfma_f32_16x16x32_bf16 v[232:235], v[248:251], v[152:155], v[232:235]
    v_mfma_f32_16x16x32_bf16 v[116:119], v[184:187], v[160:163], v[116:119]
    v_mfma_f32_16x16x32_bf16 v[236:239], v[152:155], v[152:155], v[236:239]
    v_mfma_f32_16x16x32_bf16 v[120:123], v[176:179], v[160:163], v[120:123]
    v_mfma_f32_16x16x32_bf16 v[240:243], v[248:251], v[156:159], v[240:243]
    v_mfma_f32_16x16x32_bf16 v[124:127], v[188:191], v[160:163], v[124:127]
    v_mfma_f32_16x16x32_bf16 v[244:247], v[156:159], v[156:159], v[244:247]
    v_mfma_f32_16x16x32_bf16 v[128:131], v[168:171], v[164:167], v[128:131]
    v_mfma_f32_16x16x32_bf16 v[132:135], v[180:183], v[164:167], v[132:135]
    v_mfma_f32_16x16x32_bf16 v[136:139], v[172:175], v[164:167], v[136:139]
    v_mfma_f32_16x16x32_bf16 v[140:143], v[184:187], v[164:167], v[140:143]
    v_mfma_f32_16x16x32_bf16 v[144:147], v[176:179], v[164:167], v[144:147]
    v_mfma_f32_16x16x32_bf16 v[148:151], v[188:191], v[164:167], v[148:151]
    s_waitcnt lgkmcnt(0)
    s_barrier
    v_mfma_f32_16x16x32_bf16 v[56:59], v[208:211], v[192:195], v[56:59]
    ds_read_b64_tr_b16 v[152:153], v14 offset:0
    v_mfma_f32_16x16x32_bf16 v[60:63], v[220:223], v[192:195], v[60:63]
    ds_read_b64_tr_b16 v[154:155], v14 offset:4096
    v_mfma_f32_16x16x32_bf16 v[64:67], v[212:215], v[192:195], v[64:67]
    ds_read_b64_tr_b16 v[156:157], v15 offset:0
    v_mfma_f32_16x16x32_bf16 v[68:71], v[224:227], v[192:195], v[68:71]
    ds_read_b64_tr_b16 v[158:159], v15 offset:4096
    v_mfma_f32_16x16x32_bf16 v[72:75], v[216:219], v[192:195], v[72:75]
    ds_read_b64_tr_b16 v[160:161], v16 offset:0
    v_mfma_f32_16x16x32_bf16 v[76:79], v[228:231], v[192:195], v[76:79]
    ds_read_b64_tr_b16 v[162:163], v16 offset:4096
    v_mfma_f32_16x16x32_bf16 v[80:83], v[208:211], v[196:199], v[80:83]
    ds_read_b64_tr_b16 v[164:165], v17 offset:0
    v_mfma_f32_16x16x32_bf16 v[84:87], v[220:223], v[196:199], v[84:87]
    ds_read_b64_tr_b16 v[166:167], v17 offset:4096
    v_mfma_f32_16x16x32_bf16 v[88:91], v[212:215], v[196:199], v[88:91]
    ds_read_b128 v[168:171], v24 offset:0
    v_mfma_f32_16x16x32_bf16 v[92:95], v[224:227], v[196:199], v[92:95]
    ds_read_b128 v[180:183], v24 offset:6144
    v_mfma_f32_16x16x32_bf16 v[96:99], v[216:219], v[196:199], v[96:99]
    ds_read_b128 v[172:175], v24 offset:1024
    v_mfma_f32_16x16x32_bf16 v[100:103], v[228:231], v[196:199], v[100:103]
    ds_read_b128 v[184:187], v24 offset:7168
    v_mfma_f32_16x16x32_bf16 v[104:107], v[208:211], v[200:203], v[104:107]
    ds_read_b128 v[176:179], v25 offset:0
    v_mfma_f32_16x16x32_bf16 v[108:111], v[220:223], v[200:203], v[108:111]
    ds_read_b128 v[188:191], v25 offset:6144
    v_mfma_f32_16x16x32_bf16 v[112:115], v[212:215], v[200:203], v[112:115]
    v_mfma_f32_16x16x32_bf16 v[232:235], v[248:251], v[192:195], v[232:235]
    v_mfma_f32_16x16x32_bf16 v[116:119], v[224:227], v[200:203], v[116:119]
    v_mfma_f32_16x16x32_bf16 v[236:239], v[192:195], v[192:195], v[236:239]
    v_mfma_f32_16x16x32_bf16 v[120:123], v[216:219], v[200:203], v[120:123]
    v_mfma_f32_16x16x32_bf16 v[240:243], v[248:251], v[196:199], v[240:243]
    v_mfma_f32_16x16x32_bf16 v[124:127], v[228:231], v[200:203], v[124:127]
    v_mfma_f32_16x16x32_bf16 v[244:247], v[196:199], v[196:199], v[244:247]
    v_mfma_f32_16x16x32_bf16 v[128:131], v[208:211], v[204:207], v[128:131]
    v_mfma_f32_16x16x32_bf16 v[132:135], v[220:223], v[204:207], v[132:135]
    v_mfma_f32_16x16x32_bf16 v[136:139], v[212:215], v[204:207], v[136:139]
    v_mfma_f32_16x16x32_bf16 v[140:143], v[224:227], v[204:207], v[140:143]
    v_mfma_f32_16x16x32_bf16 v[144:147], v[216:219], v[204:207], v[144:147]
    v_mfma_f32_16x16x32_bf16 v[148:151], v[228:231], v[204:207], v[148:151]
    s_waitcnt lgkmcnt(0)
    s_barrier
    v_mfma_f32_16x16x32_bf16 v[56:59], v[168:171], v[152:155], v[56:59]
    ds_read_b64_tr_b16 v[192:193], v14 offset:20480
    v_mfma_f32_16x16x32_bf16 v[60:63], v[180:183], v[152:155], v[60:63]
    ds_read_b64_tr_b16 v[194:195], v14 offset:24576
    v_mfma_f32_16x16x32_bf16 v[64:67], v[172:175], v[152:155], v[64:67]
    ds_read_b64_tr_b16 v[196:197], v15 offset:20480
    v_mfma_f32_16x16x32_bf16 v[68:71], v[184:187], v[152:155], v[68:71]
    ds_read_b64_tr_b16 v[198:199], v15 offset:24576
    v_mfma_f32_16x16x32_bf16 v[72:75], v[176:179], v[152:155], v[72:75]
    ds_read_b64_tr_b16 v[200:201], v16 offset:20480
    v_mfma_f32_16x16x32_bf16 v[76:79], v[188:191], v[152:155], v[76:79]
    ds_read_b64_tr_b16 v[202:203], v16 offset:24576
    v_mfma_f32_16x16x32_bf16 v[80:83], v[168:171], v[156:159], v[80:83]
    ds_read_b64_tr_b16 v[204:205], v17 offset:20480
    v_mfma_f32_16x16x32_bf16 v[84:87], v[180:183], v[156:159], v[84:87]
    ds_read_b64_tr_b16 v[206:207], v17 offset:24576
    v_mfma_f32_16x16x32_bf16 v[88:91], v[172:175], v[156:159], v[88:91]
    ds_read_b128 v[208:211], v24 offset:20480
    v_mfma_f32_16x16x32_bf16 v[92:95], v[184:187], v[156:159], v[92:95]
    ds_read_b128 v[220:223], v24 offset:26624
    v_mfma_f32_16x16x32_bf16 v[96:99], v[176:179], v[156:159], v[96:99]
    ds_read_b128 v[212:215], v24 offset:21504
    v_mfma_f32_16x16x32_bf16 v[100:103], v[188:191], v[156:159], v[100:103]
    ds_read_b128 v[224:227], v24 offset:27648
    v_mfma_f32_16x16x32_bf16 v[104:107], v[168:171], v[160:163], v[104:107]
    ds_read_b128 v[216:219], v25 offset:20480
    v_mfma_f32_16x16x32_bf16 v[108:111], v[180:183], v[160:163], v[108:111]
    ds_read_b128 v[228:231], v25 offset:26624
    v_mfma_f32_16x16x32_bf16 v[112:115], v[172:175], v[160:163], v[112:115]
    v_mfma_f32_16x16x32_bf16 v[232:235], v[248:251], v[152:155], v[232:235]
    v_mfma_f32_16x16x32_bf16 v[116:119], v[184:187], v[160:163], v[116:119]
    v_mfma_f32_16x16x32_bf16 v[236:239], v[152:155], v[152:155], v[236:239]
    v_mfma_f32_16x16x32_bf16 v[120:123], v[176:179], v[160:163], v[120:123]
    v_mfma_f32_16x16x32_bf16 v[240:243], v[248:251], v[156:159], v[240:243]
    v_mfma_f32_16x16x32_bf16 v[124:127], v[188:191], v[160:163], v[124:127]
    v_mfma_f32_16x16x32_bf16 v[244:247], v[156:159], v[156:159], v[244:247]
    v_mfma_f32_16x16x32_bf16 v[128:131], v[168:171], v[164:167], v[128:131]
    v_mfma_f32_16x16x32_bf16 v[132:135], v[180:183], v[164:167], v[132:135]
    v_mfma_f32_16x16x32_bf16 v[136:139], v[172:175], v[164:167], v[136:139]
    v_mfma_f32_16x16x32_bf16 v[140:143], v[184:187], v[164:167], v[140:143]
    v_mfma_f32_16x16x32_bf16 v[144:147], v[176:179], v[164:167], v[144:147]
    v_mfma_f32_16x16x32_bf16 v[148:151], v[188:191], v[164:167], v[148:151]
    s_waitcnt lgkmcnt(0)
    s_barrier
    v_mfma_f32_16x16x32_bf16 v[56:59], v[208:211], v[192:195], v[56:59]
    ds_read_b64_tr_b16 v[152:153], v14 offset:40960
    v_mfma_f32_16x16x32_bf16 v[60:63], v[220:223], v[192:195], v[60:63]
    ds_read_b64_tr_b16 v[154:155], v14 offset:45056
    v_mfma_f32_16x16x32_bf16 v[64:67], v[212:215], v[192:195], v[64:67]
    ds_read_b64_tr_b16 v[156:157], v15 offset:40960
    v_mfma_f32_16x16x32_bf16 v[68:71], v[224:227], v[192:195], v[68:71]
    ds_read_b64_tr_b16 v[158:159], v15 offset:45056
    v_mfma_f32_16x16x32_bf16 v[72:75], v[216:219], v[192:195], v[72:75]
    ds_read_b64_tr_b16 v[160:161], v16 offset:40960
    v_mfma_f32_16x16x32_bf16 v[76:79], v[228:231], v[192:195], v[76:79]
    ds_read_b64_tr_b16 v[162:163], v16 offset:45056
    v_mfma_f32_16x16x32_bf16 v[80:83], v[208:211], v[196:199], v[80:83]
    ds_read_b64_tr_b16 v[164:165], v17 offset:40960
    v_mfma_f32_16x16x32_bf16 v[84:87], v[220:223], v[196:199], v[84:87]
    ds_read_b64_tr_b16 v[166:167], v17 offset:45056
    v_mfma_f32_16x16x32_bf16 v[88:91], v[212:215], v[196:199], v[88:91]
    ds_read_b128 v[168:171], v24 offset:40960
    v_mfma_f32_16x16x32_bf16 v[92:95], v[224:227], v[196:199], v[92:95]
    ds_read_b128 v[180:183], v24 offset:47104
    v_mfma_f32_16x16x32_bf16 v[96:99], v[216:219], v[196:199], v[96:99]
    ds_read_b128 v[172:175], v24 offset:41984
    v_mfma_f32_16x16x32_bf16 v[100:103], v[228:231], v[196:199], v[100:103]
    ds_read_b128 v[184:187], v24 offset:48128
    v_mfma_f32_16x16x32_bf16 v[104:107], v[208:211], v[200:203], v[104:107]
    ds_read_b128 v[176:179], v25 offset:40960
    v_mfma_f32_16x16x32_bf16 v[108:111], v[220:223], v[200:203], v[108:111]
    ds_read_b128 v[188:191], v25 offset:47104
    v_mfma_f32_16x16x32_bf16 v[112:115], v[212:215], v[200:203], v[112:115]
    v_mfma_f32_16x16x32_bf16 v[232:235], v[248:251], v[192:195], v[232:235]
    v_mfma_f32_16x16x32_bf16 v[116:119], v[224:227], v[200:203], v[116:119]
    v_mfma_f32_16x16x32_bf16 v[236:239], v[192:195], v[192:195], v[236:239]
    v_mfma_f32_16x16x32_bf16 v[120:123], v[216:219], v[200:203], v[120:123]
    v_mfma_f32_16x16x32_bf16 v[240:243], v[248:251], v[196:199], v[240:243]
    v_mfma_f32_16x16x32_bf16 v[124:127], v[228:231], v[200:203], v[124:127]
    v_mfma_f32_16x16x32_bf16 v[244:247], v[196:199], v[196:199], v[244:247]
    v_mfma_f32_16x16x32_bf16 v[128:131], v[208:211], v[204:207], v[128:131]
    v_mfma_f32_16x16x32_bf16 v[132:135], v[220:223], v[204:207], v[132:135]
    v_mfma_f32_16x16x32_bf16 v[136:139], v[212:215], v[204:207], v[136:139]
    v_mfma_f32_16x16x32_bf16 v[140:143], v[224:227], v[204:207], v[140:143]
    v_mfma_f32_16x16x32_bf16 v[144:147], v[216:219], v[204:207], v[144:147]
    v_mfma_f32_16x16x32_bf16 v[148:151], v[228:231], v[204:207], v[148:151]
    s_waitcnt lgkmcnt(0)
    s_barrier
    v_mfma_f32_16x16x32_bf16 v[56:59], v[168:171], v[152:155], v[56:59]
    ds_read_b64_tr_b16 v[192:193], v18 offset:0
    v_mfma_f32_16x16x32_bf16 v[60:63], v[180:183], v[152:155], v[60:63]
    ds_read_b64_tr_b16 v[194:195], v18 offset:4096
    v_mfma_f32_16x16x32_bf16 v[64:67], v[172:175], v[152:155], v[64:67]
    ds_read_b64_tr_b16 v[196:197], v19 offset:0
    v_mfma_f32_16x16x32_bf16 v[68:71], v[184:187], v[152:155], v[68:71]
    ds_read_b64_tr_b16 v[198:199], v19 offset:4096
    v_mfma_f32_16x16x32_bf16 v[72:75], v[176:179], v[152:155], v[72:75]
    ds_read_b64_tr_b16 v[200:201], v20 offset:0
    v_mfma_f32_16x16x32_bf16 v[76:79], v[188:191], v[152:155], v[76:79]
    ds_read_b64_tr_b16 v[202:203], v20 offset:4096
    v_mfma_f32_16x16x32_bf16 v[80:83], v[168:171], v[156:159], v[80:83]
    ds_read_b64_tr_b16 v[204:205], v21 offset:0
    v_mfma_f32_16x16x32_bf16 v[84:87], v[180:183], v[156:159], v[84:87]
    ds_read_b64_tr_b16 v[206:207], v21 offset:4096
    v_mfma_f32_16x16x32_bf16 v[88:91], v[172:175], v[156:159], v[88:91]
    ds_read_b128 v[208:211], v26 offset:0
    v_mfma_f32_16x16x32_bf16 v[92:95], v[184:187], v[156:159], v[92:95]
    ds_read_b128 v[220:223], v26 offset:6144
    v_mfma_f32_16x16x32_bf16 v[96:99], v[176:179], v[156:159], v[96:99]
    ds_read_b128 v[212:215], v26 offset:1024
    v_mfma_f32_16x16x32_bf16 v[100:103], v[188:191], v[156:159], v[100:103]
    ds_read_b128 v[224:227], v26 offset:7168
    v_mfma_f32_16x16x32_bf16 v[104:107], v[168:171], v[160:163], v[104:107]
    ds_read_b128 v[216:219], v27 offset:0
    v_mfma_f32_16x16x32_bf16 v[108:111], v[180:183], v[160:163], v[108:111]
    ds_read_b128 v[228:231], v27 offset:6144
    v_mfma_f32_16x16x32_bf16 v[112:115], v[172:175], v[160:163], v[112:115]
    v_mfma_f32_16x16x32_bf16 v[232:235], v[248:251], v[152:155], v[232:235]
    v_mfma_f32_16x16x32_bf16 v[116:119], v[184:187], v[160:163], v[116:119]
    v_mfma_f32_16x16x32_bf16 v[236:239], v[152:155], v[152:155], v[236:239]
    v_mfma_f32_16x16x32_bf16 v[120:123], v[176:179], v[160:163], v[120:123]
    v_mfma_f32_16x16x32_bf16 v[240:243], v[248:251], v[156:159], v[240:243]
    v_mfma_f32_16x16x32_bf16 v[124:127], v[188:191], v[160:163], v[124:127]
    v_mfma_f32_16x16x32_bf16 v[244:247], v[156:159], v[156:159], v[244:247]
    v_mfma_f32_16x16x32_bf16 v[128:131], v[168:171], v[164:167], v[128:131]
    v_mfma_f32_16x16x32_bf16 v[132:135], v[180:183], v[164:167], v[132:135]
    v_mfma_f32_16x16x32_bf16 v[136:139], v[172:175], v[164:167], v[136:139]
    v_mfma_f32_16x16x32_bf16 v[140:143], v[184:187], v[164:167], v[140:143]
    v_mfma_f32_16x16x32_bf16 v[144:147], v[176:179], v[164:167], v[144:147]
    v_mfma_f32_16x16x32_bf16 v[148:151], v[188:191], v[164:167], v[148:151]
    s_waitcnt lgkmcnt(0)
    s_barrier
    v_mfma_f32_16x16x32_bf16 v[56:59], v[208:211], v[192:195], v[56:59]
    ds_read_b64_tr_b16 v[152:153], v10 offset:0
    v_mfma_f32_16x16x32_bf16 v[60:63], v[220:223], v[192:195], v[60:63]
    ds_read_b64_tr_b16 v[154:155], v10 offset:4096
    v_mfma_f32_16x16x32_bf16 v[64:67], v[212:215], v[192:195], v[64:67]
    ds_read_b64_tr_b16 v[156:157], v11 offset:0
    v_mfma_f32_16x16x32_bf16 v[68:71], v[224:227], v[192:195], v[68:71]
    ds_read_b64_tr_b16 v[158:159], v11 offset:4096
    v_mfma_f32_16x16x32_bf16 v[72:75], v[216:219], v[192:195], v[72:75]
    ds_read_b64_tr_b16 v[160:161], v12 offset:0
    v_mfma_f32_16x16x32_bf16 v[76:79], v[228:231], v[192:195], v[76:79]
    ds_read_b64_tr_b16 v[162:163], v12 offset:4096
    v_mfma_f32_16x16x32_bf16 v[80:83], v[208:211], v[196:199], v[80:83]
    ds_read_b64_tr_b16 v[164:165], v13 offset:0
    v_mfma_f32_16x16x32_bf16 v[84:87], v[220:223], v[196:199], v[84:87]
    ds_read_b64_tr_b16 v[166:167], v13 offset:4096
    v_mfma_f32_16x16x32_bf16 v[88:91], v[212:215], v[196:199], v[88:91]
    ds_read_b128 v[168:171], v22 offset:0
    v_mfma_f32_16x16x32_bf16 v[92:95], v[224:227], v[196:199], v[92:95]
    ds_read_b128 v[180:183], v22 offset:6144
    v_mfma_f32_16x16x32_bf16 v[96:99], v[216:219], v[196:199], v[96:99]
    ds_read_b128 v[172:175], v22 offset:1024
    v_mfma_f32_16x16x32_bf16 v[100:103], v[228:231], v[196:199], v[100:103]
    ds_read_b128 v[184:187], v22 offset:7168
    v_mfma_f32_16x16x32_bf16 v[104:107], v[208:211], v[200:203], v[104:107]
    ds_read_b128 v[176:179], v23 offset:0
    v_mfma_f32_16x16x32_bf16 v[108:111], v[220:223], v[200:203], v[108:111]
    ds_read_b128 v[188:191], v23 offset:6144
    v_mfma_f32_16x16x32_bf16 v[112:115], v[212:215], v[200:203], v[112:115]
    v_mfma_f32_16x16x32_bf16 v[232:235], v[248:251], v[192:195], v[232:235]
    v_mfma_f32_16x16x32_bf16 v[116:119], v[224:227], v[200:203], v[116:119]
    v_mfma_f32_16x16x32_bf16 v[236:239], v[192:195], v[192:195], v[236:239]
    v_mfma_f32_16x16x32_bf16 v[120:123], v[216:219], v[200:203], v[120:123]
    v_mfma_f32_16x16x32_bf16 v[240:243], v[248:251], v[196:199], v[240:243]
    v_mfma_f32_16x16x32_bf16 v[124:127], v[228:231], v[200:203], v[124:127]
    v_mfma_f32_16x16x32_bf16 v[244:247], v[196:199], v[196:199], v[244:247]
    v_mfma_f32_16x16x32_bf16 v[128:131], v[208:211], v[204:207], v[128:131]
    v_mfma_f32_16x16x32_bf16 v[132:135], v[220:223], v[204:207], v[132:135]
    v_mfma_f32_16x16x32_bf16 v[136:139], v[212:215], v[204:207], v[136:139]
    v_mfma_f32_16x16x32_bf16 v[140:143], v[224:227], v[204:207], v[140:143]
    v_mfma_f32_16x16x32_bf16 v[144:147], v[216:219], v[204:207], v[144:147]
    v_mfma_f32_16x16x32_bf16 v[148:151], v[228:231], v[204:207], v[148:151]
    s_waitcnt lgkmcnt(0)
    s_barrier
    v_mfma_f32_16x16x32_bf16 v[56:59], v[168:171], v[152:155], v[56:59]
    ds_read_b64_tr_b16 v[192:193], v10 offset:20480
    v_mfma_f32_16x16x32_bf16 v[60:63], v[180:183], v[152:155], v[60:63]
    ds_read_b64_tr_b16 v[194:195], v10 offset:24576
    v_mfma_f32_16x16x32_bf16 v[64:67], v[172:175], v[152:155], v[64:67]
    ds_read_b64_tr_b16 v[196:197], v11 offset:20480
    v_mfma_f32_16x16x32_bf16 v[68:71], v[184:187], v[152:155], v[68:71]
    ds_read_b64_tr_b16 v[198:199], v11 offset:24576
    v_mfma_f32_16x16x32_bf16 v[72:75], v[176:179], v[152:155], v[72:75]
    ds_read_b64_tr_b16 v[200:201], v12 offset:20480
    v_mfma_f32_16x16x32_bf16 v[76:79], v[188:191], v[152:155], v[76:79]
    ds_read_b64_tr_b16 v[202:203], v12 offset:24576
    v_mfma_f32_16x16x32_bf16 v[80:83], v[168:171], v[156:159], v[80:83]
    ds_read_b64_tr_b16 v[204:205], v13 offset:20480
    v_mfma_f32_16x16x32_bf16 v[84:87], v[180:183], v[156:159], v[84:87]
    ds_read_b64_tr_b16 v[206:207], v13 offset:24576
    v_mfma_f32_16x16x32_bf16 v[88:91], v[172:175], v[156:159], v[88:91]
    ds_read_b128 v[208:211], v22 offset:20480
    v_mfma_f32_16x16x32_bf16 v[92:95], v[184:187], v[156:159], v[92:95]
    ds_read_b128 v[220:223], v22 offset:26624
    v_mfma_f32_16x16x32_bf16 v[96:99], v[176:179], v[156:159], v[96:99]
    ds_read_b128 v[212:215], v22 offset:21504
    v_mfma_f32_16x16x32_bf16 v[100:103], v[188:191], v[156:159], v[100:103]
    ds_read_b128 v[224:227], v22 offset:27648
    v_mfma_f32_16x16x32_bf16 v[104:107], v[168:171], v[160:163], v[104:107]
    ds_read_b128 v[216:219], v23 offset:20480
    v_mfma_f32_16x16x32_bf16 v[108:111], v[180:183], v[160:163], v[108:111]
    ds_read_b128 v[228:231], v23 offset:26624
    v_mfma_f32_16x16x32_bf16 v[112:115], v[172:175], v[160:163], v[112:115]
    v_mfma_f32_16x16x32_bf16 v[232:235], v[248:251], v[152:155], v[232:235]
    v_mfma_f32_16x16x32_bf16 v[116:119], v[184:187], v[160:163], v[116:119]
    v_mfma_f32_16x16x32_bf16 v[236:239], v[152:155], v[152:155], v[236:239]
    v_mfma_f32_16x16x32_bf16 v[120:123], v[176:179], v[160:163], v[120:123]
    v_mfma_f32_16x16x32_bf16 v[240:243], v[248:251], v[156:159], v[240:243]
    v_mfma_f32_16x16x32_bf16 v[124:127], v[188:191], v[160:163], v[124:127]
    v_mfma_f32_16x16x32_bf16 v[244:247], v[156:159], v[156:159], v[244:247]
    v_mfma_f32_16x16x32_bf16 v[128:131], v[168:171], v[164:167], v[128:131]
    v_mfma_f32_16x16x32_bf16 v[132:135], v[180:183], v[164:167], v[132:135]
    v_mfma_f32_16x16x32_bf16 v[136:139], v[172:175], v[164:167], v[136:139]
    v_mfma_f32_16x16x32_bf16 v[140:143], v[184:187], v[164:167], v[140:143]
    v_mfma_f32_16x16x32_bf16 v[144:147], v[176:179], v[164:167], v[144:147]
    v_mfma_f32_16x16x32_bf16 v[148:151], v[188:191], v[164:167], v[148:151]
    s_waitcnt lgkmcnt(0)
    s_barrier
    v_mfma_f32_16x16x32_bf16 v[56:59], v[208:211], v[192:195], v[56:59]
    ds_read_b64_tr_b16 v[152:153], v10 offset:40960
    v_mfma_f32_16x16x32_bf16 v[60:63], v[220:223], v[192:195], v[60:63]
    ds_read_b64_tr_b16 v[154:155], v10 offset:45056
    v_mfma_f32_16x16x32_bf16 v[64:67], v[212:215], v[192:195], v[64:67]
    ds_read_b64_tr_b16 v[156:157], v11 offset:40960
    v_mfma_f32_16x16x32_bf16 v[68:71], v[224:227], v[192:195], v[68:71]
    ds_read_b64_tr_b16 v[158:159], v11 offset:45056
    v_mfma_f32_16x16x32_bf16 v[72:75], v[216:219], v[192:195], v[72:75]
    ds_read_b64_tr_b16 v[160:161], v12 offset:40960
    v_mfma_f32_16x16x32_bf16 v[76:79], v[228:231], v[192:195], v[76:79]
    ds_read_b64_tr_b16 v[162:163], v12 offset:45056
    v_mfma_f32_16x16x32_bf16 v[80:83], v[208:211], v[196:199], v[80:83]
    ds_read_b64_tr_b16 v[164:165], v13 offset:40960
    v_mfma_f32_16x16x32_bf16 v[84:87], v[220:223], v[196:199], v[84:87]
    ds_read_b64_tr_b16 v[166:167], v13 offset:45056
    v_mfma_f32_16x16x32_bf16 v[88:91], v[212:215], v[196:199], v[88:91]
    ds_read_b128 v[168:171], v22 offset:40960
    v_mfma_f32_16x16x32_bf16 v[92:95], v[224:227], v[196:199], v[92:95]
    ds_read_b128 v[180:183], v22 offset:47104
    v_mfma_f32_16x16x32_bf16 v[96:99], v[216:219], v[196:199], v[96:99]
    ds_read_b128 v[172:175], v22 offset:41984
    v_mfma_f32_16x16x32_bf16 v[100:103], v[228:231], v[196:199], v[100:103]
    ds_read_b128 v[184:187], v22 offset:48128
    v_mfma_f32_16x16x32_bf16 v[104:107], v[208:211], v[200:203], v[104:107]
    ds_read_b128 v[176:179], v23 offset:40960
    v_mfma_f32_16x16x32_bf16 v[108:111], v[220:223], v[200:203], v[108:111]
    ds_read_b128 v[188:191], v23 offset:47104
    v_mfma_f32_16x16x32_bf16 v[112:115], v[212:215], v[200:203], v[112:115]
    v_mfma_f32_16x16x32_bf16 v[232:235], v[248:251], v[192:195], v[232:235]
    v_mfma_f32_16x16x32_bf16 v[116:119], v[224:227], v[200:203], v[116:119]
    v_mfma_f32_16x16x32_bf16 v[236:239], v[192:195], v[192:195], v[236:239]
    v_mfma_f32_16x16x32_bf16 v[120:123], v[216:219], v[200:203], v[120:123]
    v_mfma_f32_16x16x32_bf16 v[240:243], v[248:251], v[196:199], v[240:243]
    v_mfma_f32_16x16x32_bf16 v[124:127], v[228:231], v[200:203], v[124:127]
    v_mfma_f32_16x16x32_bf16 v[244:247], v[196:199], v[196:199], v[244:247]
    v_mfma_f32_16x16x32_bf16 v[128:131], v[208:211], v[204:207], v[128:131]
    v_mfma_f32_16x16x32_bf16 v[132:135], v[220:223], v[204:207], v[132:135]
    v_mfma_f32_16x16x32_bf16 v[136:139], v[212:215], v[204:207], v[136:139]
    v_mfma_f32_16x16x32_bf16 v[140:143], v[224:227], v[204:207], v[140:143]
    v_mfma_f32_16x16x32_bf16 v[144:147], v[216:219], v[204:207], v[144:147]
    v_mfma_f32_16x16x32_bf16 v[148:151], v[228:231], v[204:207], v[148:151]
    s_waitcnt lgkmcnt(0)
    s_barrier
    v_mfma_f32_16x16x32_bf16 v[56:59], v[168:171], v[152:155], v[56:59]
    ds_read_b64_tr_b16 v[192:193], v14 offset:0
    v_mfma_f32_16x16x32_bf16 v[60:63], v[180:183], v[152:155], v[60:63]
    ds_read_b64_tr_b16 v[194:195], v14 offset:4096
    v_mfma_f32_16x16x32_bf16 v[64:67], v[172:175], v[152:155], v[64:67]
    ds_read_b64_tr_b16 v[196:197], v15 offset:0
    v_mfma_f32_16x16x32_bf16 v[68:71], v[184:187], v[152:155], v[68:71]
    ds_read_b64_tr_b16 v[198:199], v15 offset:4096
    v_mfma_f32_16x16x32_bf16 v[72:75], v[176:179], v[152:155], v[72:75]
    ds_read_b64_tr_b16 v[200:201], v16 offset:0
    v_mfma_f32_16x16x32_bf16 v[76:79], v[188:191], v[152:155], v[76:79]
    ds_read_b64_tr_b16 v[202:203], v16 offset:4096
    v_mfma_f32_16x16x32_bf16 v[80:83], v[168:171], v[156:159], v[80:83]
    ds_read_b64_tr_b16 v[204:205], v17 offset:0
    v_mfma_f32_16x16x32_bf16 v[84:87], v[180:183], v[156:159], v[84:87]
    ds_read_b64_tr_b16 v[206:207], v17 offset:4096
    v_mfma_f32_16x16x32_bf16 v[88:91], v[172:175], v[156:159], v[88:91]
    ds_read_b128 v[208:211], v24 offset:0
    v_mfma_f32_16x16x32_bf16 v[92:95], v[184:187], v[156:159], v[92:95]
    ds_read_b128 v[220:223], v24 offset:6144
    v_mfma_f32_16x16x32_bf16 v[96:99], v[176:179], v[156:159], v[96:99]
    ds_read_b128 v[212:215], v24 offset:1024
    v_mfma_f32_16x16x32_bf16 v[100:103], v[188:191], v[156:159], v[100:103]
    ds_read_b128 v[224:227], v24 offset:7168
    v_mfma_f32_16x16x32_bf16 v[104:107], v[168:171], v[160:163], v[104:107]
    ds_read_b128 v[216:219], v25 offset:0
    v_mfma_f32_16x16x32_bf16 v[108:111], v[180:183], v[160:163], v[108:111]
    ds_read_b128 v[228:231], v25 offset:6144
    v_mfma_f32_16x16x32_bf16 v[112:115], v[172:175], v[160:163], v[112:115]
    v_mfma_f32_16x16x32_bf16 v[232:235], v[248:251], v[152:155], v[232:235]
    v_mfma_f32_16x16x32_bf16 v[116:119], v[184:187], v[160:163], v[116:119]
    v_mfma_f32_16x16x32_bf16 v[236:239], v[152:155], v[152:155], v[236:239]
    v_mfma_f32_16x16x32_bf16 v[120:123], v[176:179], v[160:163], v[120:123]
    v_mfma_f32_16x16x32_bf16 v[240:243], v[248:251], v[156:159], v[240:243]
    v_mfma_f32_16x16x32_bf16 v[124:127], v[188:191], v[160:163], v[124:127]
    v_mfma_f32_16x16x32_bf16 v[244:247], v[156:159], v[156:159], v[244:247]
    v_mfma_f32_16x16x32_bf16 v[128:131], v[168:171], v[164:167], v[128:131]
    v_mfma_f32_16x16x32_bf16 v[132:135], v[180:183], v[164:167], v[132:135]
    v_mfma_f32_16x16x32_bf16 v[136:139], v[172:175], v[164:167], v[136:139]
    v_mfma_f32_16x16x32_bf16 v[140:143], v[184:187], v[164:167], v[140:143]
    v_mfma_f32_16x16x32_bf16 v[144:147], v[176:179], v[164:167], v[144:147]
    v_mfma_f32_16x16x32_bf16 v[148:151], v[188:191], v[164:167], v[148:151]
    s_waitcnt lgkmcnt(0)
    s_barrier
    v_mfma_f32_16x16x32_bf16 v[56:59], v[208:211], v[192:195], v[56:59]
    ds_read_b64_tr_b16 v[152:153], v14 offset:20480
    v_mfma_f32_16x16x32_bf16 v[60:63], v[220:223], v[192:195], v[60:63]
    ds_read_b64_tr_b16 v[154:155], v14 offset:24576
    v_mfma_f32_16x16x32_bf16 v[64:67], v[212:215], v[192:195], v[64:67]
    ds_read_b64_tr_b16 v[156:157], v15 offset:20480
    v_mfma_f32_16x16x32_bf16 v[68:71], v[224:227], v[192:195], v[68:71]
    ds_read_b64_tr_b16 v[158:159], v15 offset:24576
    v_mfma_f32_16x16x32_bf16 v[72:75], v[216:219], v[192:195], v[72:75]
    ds_read_b64_tr_b16 v[160:161], v16 offset:20480
    v_mfma_f32_16x16x32_bf16 v[76:79], v[228:231], v[192:195], v[76:79]
    ds_read_b64_tr_b16 v[162:163], v16 offset:24576
    v_mfma_f32_16x16x32_bf16 v[80:83], v[208:211], v[196:199], v[80:83]
    ds_read_b64_tr_b16 v[164:165], v17 offset:20480
    v_mfma_f32_16x16x32_bf16 v[84:87], v[220:223], v[196:199], v[84:87]
    ds_read_b64_tr_b16 v[166:167], v17 offset:24576
    v_mfma_f32_16x16x32_bf16 v[88:91], v[212:215], v[196:199], v[88:91]
    ds_read_b128 v[168:171], v24 offset:20480
    v_mfma_f32_16x16x32_bf16 v[92:95], v[224:227], v[196:199], v[92:95]
    ds_read_b128 v[180:183], v24 offset:26624
    v_mfma_f32_16x16x32_bf16 v[96:99], v[216:219], v[196:199], v[96:99]
    ds_read_b128 v[172:175], v24 offset:21504
    v_mfma_f32_16x16x32_bf16 v[100:103], v[228:231], v[196:199], v[100:103]
    ds_read_b128 v[184:187], v24 offset:27648
    v_mfma_f32_16x16x32_bf16 v[104:107], v[208:211], v[200:203], v[104:107]
    ds_read_b128 v[176:179], v25 offset:20480
    v_mfma_f32_16x16x32_bf16 v[108:111], v[220:223], v[200:203], v[108:111]
    ds_read_b128 v[188:191], v25 offset:26624
    v_mfma_f32_16x16x32_bf16 v[112:115], v[212:215], v[200:203], v[112:115]
    v_mfma_f32_16x16x32_bf16 v[232:235], v[248:251], v[192:195], v[232:235]
    v_mfma_f32_16x16x32_bf16 v[116:119], v[224:227], v[200:203], v[116:119]
    v_mfma_f32_16x16x32_bf16 v[236:239], v[192:195], v[192:195], v[236:239]
    v_mfma_f32_16x16x32_bf16 v[120:123], v[216:219], v[200:203], v[120:123]
    v_mfma_f32_16x16x32_bf16 v[240:243], v[248:251], v[196:199], v[240:243]
    v_mfma_f32_16x16x32_bf16 v[124:127], v[228:231], v[200:203], v[124:127]
    v_mfma_f32_16x16x32_bf16 v[244:247], v[196:199], v[196:199], v[244:247]
    v_mfma_f32_16x16x32_bf16 v[128:131], v[208:211], v[204:207], v[128:131]
    v_mfma_f32_16x16x32_bf16 v[132:135], v[220:223], v[204:207], v[132:135]
    v_mfma_f32_16x16x32_bf16 v[136:139], v[212:215], v[204:207], v[136:139]
    v_mfma_f32_16x16x32_bf16 v[140:143], v[224:227], v[204:207], v[140:143]
    v_mfma_f32_16x16x32_bf16 v[144:147], v[216:219], v[204:207], v[144:147]
    v_mfma_f32_16x16x32_bf16 v[148:151], v[228:231], v[204:207], v[148:151]
    s_waitcnt lgkmcnt(0)
    s_barrier
    v_mfma_f32_16x16x32_bf16 v[56:59], v[168:171], v[152:155], v[56:59]
    ds_read_b64_tr_b16 v[192:193], v14 offset:40960
    v_mfma_f32_16x16x32_bf16 v[60:63], v[180:183], v[152:155], v[60:63]
    ds_read_b64_tr_b16 v[194:195], v14 offset:45056
    v_mfma_f32_16x16x32_bf16 v[64:67], v[172:175], v[152:155], v[64:67]
    ds_read_b64_tr_b16 v[196:197], v15 offset:40960
    v_mfma_f32_16x16x32_bf16 v[68:71], v[184:187], v[152:155], v[68:71]
    ds_read_b64_tr_b16 v[198:199], v15 offset:45056
    v_mfma_f32_16x16x32_bf16 v[72:75], v[176:179], v[152:155], v[72:75]
    ds_read_b64_tr_b16 v[200:201], v16 offset:40960
    v_mfma_f32_16x16x32_bf16 v[76:79], v[188:191], v[152:155], v[76:79]
    ds_read_b64_tr_b16 v[202:203], v16 offset:45056
    v_mfma_f32_16x16x32_bf16 v[80:83], v[168:171], v[156:159], v[80:83]
    ds_read_b64_tr_b16 v[204:205], v17 offset:40960
    v_mfma_f32_16x16x32_bf16 v[84:87], v[180:183], v[156:159], v[84:87]
    ds_read_b64_tr_b16 v[206:207], v17 offset:45056
    v_mfma_f32_16x16x32_bf16 v[88:91], v[172:175], v[156:159], v[88:91]
    ds_read_b128 v[208:211], v24 offset:40960
    v_mfma_f32_16x16x32_bf16 v[92:95], v[184:187], v[156:159], v[92:95]
    ds_read_b128 v[220:223], v24 offset:47104
    v_mfma_f32_16x16x32_bf16 v[96:99], v[176:179], v[156:159], v[96:99]
    ds_read_b128 v[212:215], v24 offset:41984
    v_mfma_f32_16x16x32_bf16 v[100:103], v[188:191], v[156:159], v[100:103]
    ds_read_b128 v[224:227], v24 offset:48128
    v_mfma_f32_16x16x32_bf16 v[104:107], v[168:171], v[160:163], v[104:107]
    ds_read_b128 v[216:219], v25 offset:40960
    v_mfma_f32_16x16x32_bf16 v[108:111], v[180:183], v[160:163], v[108:111]
    ds_read_b128 v[228:231], v25 offset:47104
    v_mfma_f32_16x16x32_bf16 v[112:115], v[172:175], v[160:163], v[112:115]
    v_mfma_f32_16x16x32_bf16 v[232:235], v[248:251], v[152:155], v[232:235]
    v_mfma_f32_16x16x32_bf16 v[116:119], v[184:187], v[160:163], v[116:119]
    v_mfma_f32_16x16x32_bf16 v[236:239], v[152:155], v[152:155], v[236:239]
    v_mfma_f32_16x16x32_bf16 v[120:123], v[176:179], v[160:163], v[120:123]
    v_mfma_f32_16x16x32_bf16 v[240:243], v[248:251], v[156:159], v[240:243]
    v_mfma_f32_16x16x32_bf16 v[124:127], v[188:191], v[160:163], v[124:127]
    v_mfma_f32_16x16x32_bf16 v[244:247], v[156:159], v[156:159], v[244:247]
    v_mfma_f32_16x16x32_bf16 v[128:131], v[168:171], v[164:167], v[128:131]
    v_mfma_f32_16x16x32_bf16 v[132:135], v[180:183], v[164:167], v[132:135]
    v_mfma_f32_16x16x32_bf16 v[136:139], v[172:175], v[164:167], v[136:139]
    v_mfma_f32_16x16x32_bf16 v[140:143], v[184:187], v[164:167], v[140:143]
    v_mfma_f32_16x16x32_bf16 v[144:147], v[176:179], v[164:167], v[144:147]
    v_mfma_f32_16x16x32_bf16 v[148:151], v[188:191], v[164:167], v[148:151]
    s_waitcnt lgkmcnt(0)
    v_mfma_f32_16x16x32_bf16 v[232:235], v[248:251], v[192:195], v[232:235]
    v_mfma_f32_16x16x32_bf16 v[236:239], v[192:195], v[192:195], v[236:239]
    v_mfma_f32_16x16x32_bf16 v[240:243], v[248:251], v[196:199], v[240:243]
    v_mfma_f32_16x16x32_bf16 v[244:247], v[196:199], v[196:199], v[244:247]
    v_mfma_f32_16x16x32_bf16 v[56:59], v[208:211], v[192:195], v[56:59]
    v_mfma_f32_16x16x32_bf16 v[60:63], v[220:223], v[192:195], v[60:63]
    v_mfma_f32_16x16x32_bf16 v[64:67], v[212:215], v[192:195], v[64:67]
    v_mfma_f32_16x16x32_bf16 v[68:71], v[224:227], v[192:195], v[68:71]
    v_mfma_f32_16x16x32_bf16 v[72:75], v[216:219], v[192:195], v[72:75]
    v_mfma_f32_16x16x32_bf16 v[76:79], v[228:231], v[192:195], v[76:79]
    v_mfma_f32_16x16x32_bf16 v[80:83], v[208:211], v[196:199], v[80:83]
    v_mfma_f32_16x16x32_bf16 v[84:87], v[220:223], v[196:199], v[84:87]
    v_and_b32 v3, 3, v1
    v_bfe_u32 v4, v1, 2, 2
    v_lshrrev_b32 v5, 4, v1
    v_cmp_eq_u32 s[42:43], v4, v5
    v_cmp_eq_u32 s[44:45], 1, v3
    v_cmp_eq_u32 s[46:47], 2, v3
    v_cmp_eq_u32 s[48:49], 3, v3
    v_mov_b32 v28, v232
    v_cndmask_b32 v30, v236, v237, s[44:45]
    v_cndmask_b32 v30, v30, v238, s[46:47]
    v_cndmask_b32 v30, v30, v239, s[48:49]
    v_cndmask_b32 v30, 0, v30, s[42:43]
    v_mov_b32 v29, v240
    v_cndmask_b32 v31, v244, v245, s[44:45]
    v_cndmask_b32 v31, v31, v246, s[46:47]
    v_cndmask_b32 v31, v31, v247, s[48:49]
    v_cndmask_b32 v31, 0, v31, s[42:43]
    v_mov_b32 v2, v30
    v_mov_b32 v3, v31
    s_nop 1
    v_permlane32_swap_b32 v30, v2
    v_permlane32_swap_b32 v31, v3
    s_nop 1
    v_add_f32 v30, v30, v2
    v_add_f32 v31, v31, v3
    v_mov_b32 v2, v30
    v_mov_b32 v3, v31
    s_nop 1
    v_permlane16_swap_b32 v30, v2
    v_permlane16_swap_b32 v31, v3
    s_nop 1
    v_add_f32 v30, v30, v2
    v_add_f32 v31, v31, v3
    s_mov_b32 s32, 0x3acccccd
    v_and_b32 v3, 15, v1
    v_lshlrev_b32 v3, 4, v3
    v_mfma_f32_16x16x32_bf16 v[88:91], v[212:215], v[196:199], v[88:91]
    v_mul_f32 v28, s32, v28
    v_mul_f32 v30, s32, v30
    v_mfma_f32_16x16x32_bf16 v[92:95], v[224:227], v[196:199], v[92:95]
    v_fma_f32 v30, -v28, v28, v30
    v_max_f32 v30, 0, v30
    v_mfma_f32_16x16x32_bf16 v[96:99], v[216:219], v[196:199], v[96:99]
    v_cvt_pk_bf16_f32 v28, v28, v30
    v_lshlrev_b32 v152, 16, v28
    v_mfma_f32_16x16x32_bf16 v[100:103], v[228:231], v[196:199], v[100:103]
    v_and_b32 v30, 0xffff0000, v28
    v_add_f32 v30, 0x3727c5ac, v30
    v_mfma_f32_16x16x32_bf16 v[104:107], v[208:211], v[200:203], v[104:107]
    v_cvt_pk_bf16_f32 v30, v30, v30
    v_and_b32 v30, 0xffff0000, v30
    v_mfma_f32_16x16x32_bf16 v[108:111], v[220:223], v[200:203], v[108:111]
    v_sqrt_f32 v30, v30
    v_xor_b32 v152, 0x80000000, v152
    v_mfma_f32_16x16x32_bf16 v[112:115], v[212:215], v[200:203], v[112:115]
    v_cvt_pk_bf16_f32 v30, v30, v30
    v_and_b32 v30, 0xffff0000, v30
    v_mfma_f32_16x16x32_bf16 v[116:119], v[224:227], v[200:203], v[116:119]
    v_rcp_f32 v153, v30
    v_mul_f32 v154, v30, v30
    v_mfma_f32_16x16x32_bf16 v[120:123], v[216:219], v[200:203], v[120:123]
    s_lshl_b32 s33, s36, 8
    s_add_u32 s33, s33, 143360
    v_mfma_f32_16x16x32_bf16 v[124:127], v[228:231], v[200:203], v[124:127]
    v_add_u32 v4, s33, v3
    ds_write_b128 v4, v[152:155]
    v_mfma_f32_16x16x32_bf16 v[128:131], v[208:211], v[204:207], v[128:131]
    v_mul_f32 v29, s32, v29
    v_mul_f32 v31, s32, v31
    v_mfma_f32_16x16x32_bf16 v[132:135], v[220:223], v[204:207], v[132:135]
    v_fma_f32 v31, -v29, v29, v31
    v_max_f32 v31, 0, v31
    v_mfma_f32_16x16x32_bf16 v[136:139], v[212:215], v[204:207], v[136:139]
    v_cvt_pk_bf16_f32 v29, v29, v31
    v_lshlrev_b32 v156, 16, v29
    v_mfma_f32_16x16x32_bf16 v[140:143], v[224:227], v[204:207], v[140:143]
    v_and_b32 v31, 0xffff0000, v29
    v_add_f32 v31, 0x3727c5ac, v31
    v_mfma_f32_16x16x32_bf16 v[144:147], v[216:219], v[204:207], v[144:147]
    v_cvt_pk_bf16_f32 v31, v31, v31
    v_and_b32 v31, 0xffff0000, v31
    v_mfma_f32_16x16x32_bf16 v[148:151], v[228:231], v[204:207], v[148:151]
    v_sqrt_f32 v31, v31
    v_xor_b32 v156, 0x80000000, v156
    v_cvt_pk_bf16_f32 v31, v31, v31
    v_and_b32 v31, 0xffff0000, v31
    v_rcp_f32 v157, v31
    v_mul_f32 v158, v31, v31
    s_lshl_b32 s33, s37, 8
    s_add_u32 s33, s33, 143360
    v_add_u32 v5, s33, v3
    ds_write_b128 v5, v[156:159]
    s_waitcnt lgkmcnt(0)
    s_lshl_b32 s33, s38, 8
    s_add_u32 s33, s33, 143360
    v_add_u32 v8, s33, v3
    s_lshl_b32 s33, s39, 8
    s_add_u32 s33, s33, 143360
    v_add_u32 v9, s33, v3
    s_lshl_b32 s21, s16, 3
    s_mul_i32 s22, s17, 3
    s_lshl_b32 s26, s20, 11
    s_lshl_b32 s23, s20, 3
    s_add_u32 s23, s23, 1024
    v_lshlrev_b32 v4, 4, v1
    v_add_u32 v5, s23, v4
    v_add_u32 v4, s26, v4
    s_mov_b32 s34, 0xbdd2d3e8
    s_mov_b32 s35, 0xbdd2d3e8
    v_mov_b32 v6, 0xc0135761
    v_mov_b32 v7, 0xc0135761
    s_waitcnt vmcnt(0)
    v_pk_fma_f32 v[56:57], v[32:33], v[152:153], v[56:57] op_sel_hi:[1,0,1]
    v_pk_fma_f32 v[58:59], v[34:35], v[152:153], v[58:59] op_sel_hi:[1,0,1]
    v_pk_fma_f32 v[64:65], v[40:41], v[152:153], v[64:65] op_sel_hi:[1,0,1]
    v_pk_fma_f32 v[66:67], v[42:43], v[152:153], v[66:67] op_sel_hi:[1,0,1]
    v_pk_fma_f32 v[72:73], v[48:49], v[152:153], v[72:73] op_sel_hi:[1,0,1]
    v_pk_fma_f32 v[74:75], v[50:51], v[152:153], v[74:75] op_sel_hi:[1,0,1]
    v_pk_fma_f32 v[60:61], v[36:37], v[152:153], v[60:61] op_sel_hi:[1,0,1]
    v_pk_fma_f32 v[62:63], v[38:39], v[152:153], v[62:63] op_sel_hi:[1,0,1]
    v_pk_fma_f32 v[68:69], v[44:45], v[152:153], v[68:69] op_sel_hi:[1,0,1]
    v_pk_fma_f32 v[70:71], v[46:47], v[152:153], v[70:71] op_sel_hi:[1,0,1]
    v_pk_fma_f32 v[76:77], v[52:53], v[152:153], v[76:77] op_sel_hi:[1,0,1]
    v_pk_fma_f32 v[78:79], v[54:55], v[152:153], v[78:79] op_sel_hi:[1,0,1]
    v_pk_mul_f32 v[60:61], v[60:61], v[56:57]
    v_pk_mul_f32 v[62:63], v[62:63], v[58:59]
    v_pk_mul_f32 v[68:69], v[68:69], v[64:65]
    v_pk_mul_f32 v[70:71], v[70:71], v[66:67]
    v_pk_mul_f32 v[76:77], v[76:77], v[72:73]
    v_pk_mul_f32 v[78:79], v[78:79], v[74:75]
    v_pk_mul_f32 v[56:57], v[56:57], v[152:153] op_sel:[0,1] op_sel_hi:[1,1]
    v_pk_mul_f32 v[58:59], v[58:59], v[152:153] op_sel:[0,1] op_sel_hi:[1,1]
    v_pk_mul_f32 v[64:65], v[64:65], v[152:153] op_sel:[0,1] op_sel_hi:[1,1]
    v_pk_mul_f32 v[66:67], v[66:67], v[152:153] op_sel:[0,1] op_sel_hi:[1,1]
    v_pk_mul_f32 v[72:73], v[72:73], v[152:153] op_sel:[0,1] op_sel_hi:[1,1]
    v_pk_mul_f32 v[74:75], v[74:75], v[152:153] op_sel:[0,1] op_sel_hi:[1,1]
    v_pk_mul_f32 v[168:169], v[56:57], v[56:57]
    v_pk_mul_f32 v[170:171], v[58:59], v[58:59]
    v_pk_mul_f32 v[172:173], v[64:65], v[64:65]
    v_pk_mul_f32 v[174:175], v[66:67], v[66:67]
    v_pk_mul_f32 v[176:177], v[72:73], v[72:73]
    v_pk_mul_f32 v[178:179], v[74:75], v[74:75]
    v_pk_fma_f32 v[168:169], v[168:169], s[34:35], v[6:7]
    v_pk_fma_f32 v[170:171], v[170:171], s[34:35], v[6:7]
    v_pk_fma_f32 v[172:173], v[172:173], s[34:35], v[6:7]
    v_pk_fma_f32 v[174:175], v[174:175], s[34:35], v[6:7]
    v_pk_fma_f32 v[176:177], v[176:177], s[34:35], v[6:7]
    v_pk_fma_f32 v[178:179], v[178:179], s[34:35], v[6:7]
    v_pk_mul_f32 v[168:169], v[168:169], v[56:57]
    v_pk_mul_f32 v[170:171], v[170:171], v[58:59]
    v_pk_mul_f32 v[172:173], v[172:173], v[64:65]
    v_pk_mul_f32 v[174:175], v[174:175], v[66:67]
    v_pk_mul_f32 v[176:177], v[176:177], v[72:73]
    v_pk_mul_f32 v[178:179], v[178:179], v[74:75]
    v_exp_f32 v168, v168
    v_exp_f32 v169, v169
    v_exp_f32 v170, v170
    v_exp_f32 v171, v171
    v_exp_f32 v172, v172
    v_exp_f32 v173, v173
    v_exp_f32 v174, v174
    v_exp_f32 v175, v175
    v_exp_f32 v176, v176
    v_exp_f32 v177, v177
    v_exp_f32 v178, v178
    v_exp_f32 v179, v179
    s_add_u32 s27, s21, s36
    s_mul_i32 s27, s27, 48
    v_pk_fma_f32 v[168:169], v[168:169], v[154:155], v[154:155] op_sel_hi:[1,0,0]
    v_pk_fma_f32 v[170:171], v[170:171], v[154:155], v[154:155] op_sel_hi:[1,0,0]
    v_pk_fma_f32 v[172:173], v[172:173], v[154:155], v[154:155] op_sel_hi:[1,0,0]
    v_pk_fma_f32 v[174:175], v[174:175], v[154:155], v[154:155] op_sel_hi:[1,0,0]
    v_pk_fma_f32 v[176:177], v[176:177], v[154:155], v[154:155] op_sel_hi:[1,0,0]
    v_pk_fma_f32 v[178:179], v[178:179], v[154:155], v[154:155] op_sel_hi:[1,0,0]
    v_rcp_f32 v168, v168
    v_rcp_f32 v169, v169
    v_rcp_f32 v170, v170
    v_rcp_f32 v171, v171
    v_rcp_f32 v172, v172
    v_rcp_f32 v173, v173
    v_rcp_f32 v174, v174
    v_rcp_f32 v175, v175
    v_rcp_f32 v176, v176
    v_rcp_f32 v177, v177
    v_rcp_f32 v178, v178
    v_rcp_f32 v179, v179
    s_add_u32 s27, s27, s22
    s_lshl_b32 s27, s27, 10
    s_add_u32 s27, s27, 8388608
    v_pk_mul_f32 v[168:169], v[168:169], v[60:61]
    v_pk_mul_f32 v[170:171], v[170:171], v[62:63]
    v_pk_mul_f32 v[172:173], v[172:173], v[68:69]
    v_pk_mul_f32 v[174:175], v[174:175], v[70:71]
    v_pk_mul_f32 v[176:177], v[176:177], v[76:77]
    v_pk_mul_f32 v[178:179], v[178:179], v[78:79]
    v_cvt_pk_bf16_f32 v184, v168, v169
    v_cvt_pk_bf16_f32 v185, v170, v171
    v_cvt_pk_bf16_f32 v186, v172, v173
    v_cvt_pk_bf16_f32 v187, v174, v175
    v_cvt_pk_bf16_f32 v188, v176, v177
    v_cvt_pk_bf16_f32 v189, v178, v179
    buffer_store_dwordx4 v[184:187], v4, s[28:31], s27 offen
    buffer_store_dwordx2 v[188:189], v5, s[28:31], s27 offen
    s_barrier
    ds_read_b128 v[160:163], v8
    ds_read_b128 v[164:167], v9
    v_pk_fma_f32 v[80:81], v[32:33], v[156:157], v[80:81] op_sel_hi:[1,0,1]
    v_pk_fma_f32 v[82:83], v[34:35], v[156:157], v[82:83] op_sel_hi:[1,0,1]
    v_pk_fma_f32 v[88:89], v[40:41], v[156:157], v[88:89] op_sel_hi:[1,0,1]
    v_pk_fma_f32 v[90:91], v[42:43], v[156:157], v[90:91] op_sel_hi:[1,0,1]
    v_pk_fma_f32 v[96:97], v[48:49], v[156:157], v[96:97] op_sel_hi:[1,0,1]
    v_pk_fma_f32 v[98:99], v[50:51], v[156:157], v[98:99] op_sel_hi:[1,0,1]
    v_pk_fma_f32 v[84:85], v[36:37], v[156:157], v[84:85] op_sel_hi:[1,0,1]
    v_pk_fma_f32 v[86:87], v[38:39], v[156:157], v[86:87] op_sel_hi:[1,0,1]
    v_pk_fma_f32 v[92:93], v[44:45], v[156:157], v[92:93] op_sel_hi:[1,0,1]
    v_pk_fma_f32 v[94:95], v[46:47], v[156:157], v[94:95] op_sel_hi:[1,0,1]
    v_pk_fma_f32 v[100:101], v[52:53], v[156:157], v[100:101] op_sel_hi:[1,0,1]
    v_pk_fma_f32 v[102:103], v[54:55], v[156:157], v[102:103] op_sel_hi:[1,0,1]
    v_pk_mul_f32 v[84:85], v[84:85], v[80:81]
    v_pk_mul_f32 v[86:87], v[86:87], v[82:83]
    v_pk_mul_f32 v[92:93], v[92:93], v[88:89]
    v_pk_mul_f32 v[94:95], v[94:95], v[90:91]
    v_pk_mul_f32 v[100:101], v[100:101], v[96:97]
    v_pk_mul_f32 v[102:103], v[102:103], v[98:99]
    v_pk_mul_f32 v[80:81], v[80:81], v[156:157] op_sel:[0,1] op_sel_hi:[1,1]
    v_pk_mul_f32 v[82:83], v[82:83], v[156:157] op_sel:[0,1] op_sel_hi:[1,1]
    v_pk_mul_f32 v[88:89], v[88:89], v[156:157] op_sel:[0,1] op_sel_hi:[1,1]
    v_pk_mul_f32 v[90:91], v[90:91], v[156:157] op_sel:[0,1] op_sel_hi:[1,1]
    v_pk_mul_f32 v[96:97], v[96:97], v[156:157] op_sel:[0,1] op_sel_hi:[1,1]
    v_pk_mul_f32 v[98:99], v[98:99], v[156:157] op_sel:[0,1] op_sel_hi:[1,1]
    v_pk_mul_f32 v[168:169], v[80:81], v[80:81]
    v_pk_mul_f32 v[170:171], v[82:83], v[82:83]
    v_pk_mul_f32 v[172:173], v[88:89], v[88:89]
    v_pk_mul_f32 v[174:175], v[90:91], v[90:91]
    v_pk_mul_f32 v[176:177], v[96:97], v[96:97]
    v_pk_mul_f32 v[178:179], v[98:99], v[98:99]
    v_pk_fma_f32 v[168:169], v[168:169], s[34:35], v[6:7]
    v_pk_fma_f32 v[170:171], v[170:171], s[34:35], v[6:7]
    v_pk_fma_f32 v[172:173], v[172:173], s[34:35], v[6:7]
    v_pk_fma_f32 v[174:175], v[174:175], s[34:35], v[6:7]
    v_pk_fma_f32 v[176:177], v[176:177], s[34:35], v[6:7]
    v_pk_fma_f32 v[178:179], v[178:179], s[34:35], v[6:7]
    v_pk_mul_f32 v[168:169], v[168:169], v[80:81]
    v_pk_mul_f32 v[170:171], v[170:171], v[82:83]
    v_pk_mul_f32 v[172:173], v[172:173], v[88:89]
    v_pk_mul_f32 v[174:175], v[174:175], v[90:91]
    v_pk_mul_f32 v[176:177], v[176:177], v[96:97]
    v_pk_mul_f32 v[178:179], v[178:179], v[98:99]
    v_exp_f32 v168, v168
    v_exp_f32 v169, v169
    v_exp_f32 v170, v170
    v_exp_f32 v171, v171
    v_exp_f32 v172, v172
    v_exp_f32 v173, v173
    v_exp_f32 v174, v174
    v_exp_f32 v175, v175
    v_exp_f32 v176, v176
    v_exp_f32 v177, v177
    v_exp_f32 v178, v178
    v_exp_f32 v179, v179
    s_add_u32 s27, s21, s37
    s_mul_i32 s27, s27, 48
    v_pk_fma_f32 v[168:169], v[168:169], v[158:159], v[158:159] op_sel_hi:[1,0,0]
    v_pk_fma_f32 v[170:171], v[170:171], v[158:159], v[158:159] op_sel_hi:[1,0,0]
    v_pk_fma_f32 v[172:173], v[172:173], v[158:159], v[158:159] op_sel_hi:[1,0,0]
    v_pk_fma_f32 v[174:175], v[174:175], v[158:159], v[158:159] op_sel_hi:[1,0,0]
    v_pk_fma_f32 v[176:177], v[176:177], v[158:159], v[158:159] op_sel_hi:[1,0,0]
    v_pk_fma_f32 v[178:179], v[178:179], v[158:159], v[158:159] op_sel_hi:[1,0,0]
    v_rcp_f32 v168, v168
    v_rcp_f32 v169, v169
    v_rcp_f32 v170, v170
    v_rcp_f32 v171, v171
    v_rcp_f32 v172, v172
    v_rcp_f32 v173, v173
    v_rcp_f32 v174, v174
    v_rcp_f32 v175, v175
    v_rcp_f32 v176, v176
    v_rcp_f32 v177, v177
    v_rcp_f32 v178, v178
    v_rcp_f32 v179, v179
    s_add_u32 s27, s27, s22
    s_lshl_b32 s27, s27, 10
    s_add_u32 s27, s27, 8388608
    v_pk_mul_f32 v[168:169], v[168:169], v[84:85]
    v_pk_mul_f32 v[170:171], v[170:171], v[86:87]
    v_pk_mul_f32 v[172:173], v[172:173], v[92:93]
    v_pk_mul_f32 v[174:175], v[174:175], v[94:95]
    v_pk_mul_f32 v[176:177], v[176:177], v[100:101]
    v_pk_mul_f32 v[178:179], v[178:179], v[102:103]
    v_cvt_pk_bf16_f32 v192, v168, v169
    v_cvt_pk_bf16_f32 v193, v170, v171
    v_cvt_pk_bf16_f32 v194, v172, v173
    v_cvt_pk_bf16_f32 v195, v174, v175
    v_cvt_pk_bf16_f32 v196, v176, v177
    v_cvt_pk_bf16_f32 v197, v178, v179
    buffer_store_dwordx4 v[192:195], v4, s[28:31], s27 offen
    buffer_store_dwordx2 v[196:197], v5, s[28:31], s27 offen
    s_waitcnt lgkmcnt(0)
    v_pk_fma_f32 v[104:105], v[32:33], v[160:161], v[104:105] op_sel_hi:[1,0,1]
    v_pk_fma_f32 v[106:107], v[34:35], v[160:161], v[106:107] op_sel_hi:[1,0,1]
    v_pk_fma_f32 v[112:113], v[40:41], v[160:161], v[112:113] op_sel_hi:[1,0,1]
    v_pk_fma_f32 v[114:115], v[42:43], v[160:161], v[114:115] op_sel_hi:[1,0,1]
    v_pk_fma_f32 v[120:121], v[48:49], v[160:161], v[120:121] op_sel_hi:[1,0,1]
    v_pk_fma_f32 v[122:123], v[50:51], v[160:161], v[122:123] op_sel_hi:[1,0,1]
    v_pk_fma_f32 v[108:109], v[36:37], v[160:161], v[108:109] op_sel_hi:[1,0,1]
    v_pk_fma_f32 v[110:111], v[38:39], v[160:161], v[110:111] op_sel_hi:[1,0,1]
    v_pk_fma_f32 v[116:117], v[44:45], v[160:161], v[116:117] op_sel_hi:[1,0,1]
    v_pk_fma_f32 v[118:119], v[46:47], v[160:161], v[118:119] op_sel_hi:[1,0,1]
    v_pk_fma_f32 v[124:125], v[52:53], v[160:161], v[124:125] op_sel_hi:[1,0,1]
    v_pk_fma_f32 v[126:127], v[54:55], v[160:161], v[126:127] op_sel_hi:[1,0,1]
    v_pk_mul_f32 v[108:109], v[108:109], v[104:105]
    v_pk_mul_f32 v[110:111], v[110:111], v[106:107]
    v_pk_mul_f32 v[116:117], v[116:117], v[112:113]
    v_pk_mul_f32 v[118:119], v[118:119], v[114:115]
    v_pk_mul_f32 v[124:125], v[124:125], v[120:121]
    v_pk_mul_f32 v[126:127], v[126:127], v[122:123]
    v_pk_mul_f32 v[104:105], v[104:105], v[160:161] op_sel:[0,1] op_sel_hi:[1,1]
    v_pk_mul_f32 v[106:107], v[106:107], v[160:161] op_sel:[0,1] op_sel_hi:[1,1]
    v_pk_mul_f32 v[112:113], v[112:113], v[160:161] op_sel:[0,1] op_sel_hi:[1,1]
    v_pk_mul_f32 v[114:115], v[114:115], v[160:161] op_sel:[0,1] op_sel_hi:[1,1]
    v_pk_mul_f32 v[120:121], v[120:121], v[160:161] op_sel:[0,1] op_sel_hi:[1,1]
    v_pk_mul_f32 v[122:123], v[122:123], v[160:161] op_sel:[0,1] op_sel_hi:[1,1]
    v_pk_mul_f32 v[168:169], v[104:105], v[104:105]
    v_pk_mul_f32 v[170:171], v[106:107], v[106:107]
    v_pk_mul_f32 v[172:173], v[112:113], v[112:113]
    v_pk_mul_f32 v[174:175], v[114:115], v[114:115]
    v_pk_mul_f32 v[176:177], v[120:121], v[120:121]
    v_pk_mul_f32 v[178:179], v[122:123], v[122:123]
    v_pk_fma_f32 v[168:169], v[168:169], s[34:35], v[6:7]
    v_pk_fma_f32 v[170:171], v[170:171], s[34:35], v[6:7]
    v_pk_fma_f32 v[172:173], v[172:173], s[34:35], v[6:7]
    v_pk_fma_f32 v[174:175], v[174:175], s[34:35], v[6:7]
    v_pk_fma_f32 v[176:177], v[176:177], s[34:35], v[6:7]
    v_pk_fma_f32 v[178:179], v[178:179], s[34:35], v[6:7]
    v_pk_mul_f32 v[168:169], v[168:169], v[104:105]
    v_pk_mul_f32 v[170:171], v[170:171], v[106:107]
    v_pk_mul_f32 v[172:173], v[172:173], v[112:113]
    v_pk_mul_f32 v[174:175], v[174:175], v[114:115]
    v_pk_mul_f32 v[176:177], v[176:177], v[120:121]
    v_pk_mul_f32 v[178:179], v[178:179], v[122:123]
    v_exp_f32 v168, v168
    v_exp_f32 v169, v169
    v_exp_f32 v170, v170
    v_exp_f32 v171, v171
    v_exp_f32 v172, v172
    v_exp_f32 v173, v173
    v_exp_f32 v174, v174
    v_exp_f32 v175, v175
    v_exp_f32 v176, v176
    v_exp_f32 v177, v177
    v_exp_f32 v178, v178
    v_exp_f32 v179, v179
    s_add_u32 s27, s21, s38
    s_mul_i32 s27, s27, 48
    v_pk_fma_f32 v[168:169], v[168:169], v[162:163], v[162:163] op_sel_hi:[1,0,0]
    v_pk_fma_f32 v[170:171], v[170:171], v[162:163], v[162:163] op_sel_hi:[1,0,0]
    v_pk_fma_f32 v[172:173], v[172:173], v[162:163], v[162:163] op_sel_hi:[1,0,0]
    v_pk_fma_f32 v[174:175], v[174:175], v[162:163], v[162:163] op_sel_hi:[1,0,0]
    v_pk_fma_f32 v[176:177], v[176:177], v[162:163], v[162:163] op_sel_hi:[1,0,0]
    v_pk_fma_f32 v[178:179], v[178:179], v[162:163], v[162:163] op_sel_hi:[1,0,0]
    v_rcp_f32 v168, v168
    v_rcp_f32 v169, v169
    v_rcp_f32 v170, v170
    v_rcp_f32 v171, v171
    v_rcp_f32 v172, v172
    v_rcp_f32 v173, v173
    v_rcp_f32 v174, v174
    v_rcp_f32 v175, v175
    v_rcp_f32 v176, v176
    v_rcp_f32 v177, v177
    v_rcp_f32 v178, v178
    v_rcp_f32 v179, v179
    s_add_u32 s27, s27, s22
    s_lshl_b32 s27, s27, 10
    s_add_u32 s27, s27, 8388608
    v_pk_mul_f32 v[168:169], v[168:169], v[108:109]
    v_pk_mul_f32 v[170:171], v[170:171], v[110:111]
    v_pk_mul_f32 v[172:173], v[172:173], v[116:117]
    v_pk_mul_f32 v[174:175], v[174:175], v[118:119]
    v_pk_mul_f32 v[176:177], v[176:177], v[124:125]
    v_pk_mul_f32 v[178:179], v[178:179], v[126:127]
    v_cvt_pk_bf16_f32 v200, v168, v169
    v_cvt_pk_bf16_f32 v201, v170, v171
    v_cvt_pk_bf16_f32 v202, v172, v173
    v_cvt_pk_bf16_f32 v203, v174, v175
    v_cvt_pk_bf16_f32 v204, v176, v177
    v_cvt_pk_bf16_f32 v205, v178, v179
    buffer_store_dwordx4 v[200:203], v4, s[28:31], s27 offen
    buffer_store_dwordx2 v[204:205], v5, s[28:31], s27 offen
    v_pk_fma_f32 v[128:129], v[32:33], v[164:165], v[128:129] op_sel_hi:[1,0,1]
    v_pk_fma_f32 v[130:131], v[34:35], v[164:165], v[130:131] op_sel_hi:[1,0,1]
    v_pk_fma_f32 v[136:137], v[40:41], v[164:165], v[136:137] op_sel_hi:[1,0,1]
    v_pk_fma_f32 v[138:139], v[42:43], v[164:165], v[138:139] op_sel_hi:[1,0,1]
    v_pk_fma_f32 v[144:145], v[48:49], v[164:165], v[144:145] op_sel_hi:[1,0,1]
    v_pk_fma_f32 v[146:147], v[50:51], v[164:165], v[146:147] op_sel_hi:[1,0,1]
    v_pk_fma_f32 v[132:133], v[36:37], v[164:165], v[132:133] op_sel_hi:[1,0,1]
    v_pk_fma_f32 v[134:135], v[38:39], v[164:165], v[134:135] op_sel_hi:[1,0,1]
    v_pk_fma_f32 v[140:141], v[44:45], v[164:165], v[140:141] op_sel_hi:[1,0,1]
    v_pk_fma_f32 v[142:143], v[46:47], v[164:165], v[142:143] op_sel_hi:[1,0,1]
    v_pk_fma_f32 v[148:149], v[52:53], v[164:165], v[148:149] op_sel_hi:[1,0,1]
    v_pk_fma_f32 v[150:151], v[54:55], v[164:165], v[150:151] op_sel_hi:[1,0,1]
    v_pk_mul_f32 v[132:133], v[132:133], v[128:129]
    v_pk_mul_f32 v[134:135], v[134:135], v[130:131]
    v_pk_mul_f32 v[140:141], v[140:141], v[136:137]
    v_pk_mul_f32 v[142:143], v[142:143], v[138:139]
    v_pk_mul_f32 v[148:149], v[148:149], v[144:145]
    v_pk_mul_f32 v[150:151], v[150:151], v[146:147]
    v_pk_mul_f32 v[128:129], v[128:129], v[164:165] op_sel:[0,1] op_sel_hi:[1,1]
    v_pk_mul_f32 v[130:131], v[130:131], v[164:165] op_sel:[0,1] op_sel_hi:[1,1]
    v_pk_mul_f32 v[136:137], v[136:137], v[164:165] op_sel:[0,1] op_sel_hi:[1,1]
    v_pk_mul_f32 v[138:139], v[138:139], v[164:165] op_sel:[0,1] op_sel_hi:[1,1]
    v_pk_mul_f32 v[144:145], v[144:145], v[164:165] op_sel:[0,1] op_sel_hi:[1,1]
    v_pk_mul_f32 v[146:147], v[146:147], v[164:165] op_sel:[0,1] op_sel_hi:[1,1]
    v_pk_mul_f32 v[168:169], v[128:129], v[128:129]
    v_pk_mul_f32 v[170:171], v[130:131], v[130:131]
    v_pk_mul_f32 v[172:173], v[136:137], v[136:137]
    v_pk_mul_f32 v[174:175], v[138:139], v[138:139]
    v_pk_mul_f32 v[176:177], v[144:145], v[144:145]
    v_pk_mul_f32 v[178:179], v[146:147], v[146:147]
    v_pk_fma_f32 v[168:169], v[168:169], s[34:35], v[6:7]
    v_pk_fma_f32 v[170:171], v[170:171], s[34:35], v[6:7]
    v_pk_fma_f32 v[172:173], v[172:173], s[34:35], v[6:7]
    v_pk_fma_f32 v[174:175], v[174:175], s[34:35], v[6:7]
    v_pk_fma_f32 v[176:177], v[176:177], s[34:35], v[6:7]
    v_pk_fma_f32 v[178:179], v[178:179], s[34:35], v[6:7]
    v_pk_mul_f32 v[168:169], v[168:169], v[128:129]
    v_pk_mul_f32 v[170:171], v[170:171], v[130:131]
    v_pk_mul_f32 v[172:173], v[172:173], v[136:137]
    v_pk_mul_f32 v[174:175], v[174:175], v[138:139]
    v_pk_mul_f32 v[176:177], v[176:177], v[144:145]
    v_pk_mul_f32 v[178:179], v[178:179], v[146:147]
    v_exp_f32 v168, v168
    v_exp_f32 v169, v169
    v_exp_f32 v170, v170
    v_exp_f32 v171, v171
    v_exp_f32 v172, v172
    v_exp_f32 v173, v173
    v_exp_f32 v174, v174
    v_exp_f32 v175, v175
    v_exp_f32 v176, v176
    v_exp_f32 v177, v177
    v_exp_f32 v178, v178
    v_exp_f32 v179, v179
    s_add_u32 s27, s21, s39
    s_mul_i32 s27, s27, 48
    v_pk_fma_f32 v[168:169], v[168:169], v[166:167], v[166:167] op_sel_hi:[1,0,0]
    v_pk_fma_f32 v[170:171], v[170:171], v[166:167], v[166:167] op_sel_hi:[1,0,0]
    v_pk_fma_f32 v[172:173], v[172:173], v[166:167], v[166:167] op_sel_hi:[1,0,0]
    v_pk_fma_f32 v[174:175], v[174:175], v[166:167], v[166:167] op_sel_hi:[1,0,0]
    v_pk_fma_f32 v[176:177], v[176:177], v[166:167], v[166:167] op_sel_hi:[1,0,0]
    v_pk_fma_f32 v[178:179], v[178:179], v[166:167], v[166:167] op_sel_hi:[1,0,0]
    v_rcp_f32 v168, v168
    v_rcp_f32 v169, v169
    v_rcp_f32 v170, v170
    v_rcp_f32 v171, v171
    v_rcp_f32 v172, v172
    v_rcp_f32 v173, v173
    v_rcp_f32 v174, v174
    v_rcp_f32 v175, v175
    v_rcp_f32 v176, v176
    v_rcp_f32 v177, v177
    v_rcp_f32 v178, v178
    v_rcp_f32 v179, v179
    s_add_u32 s27, s27, s22
    s_lshl_b32 s27, s27, 10
    s_add_u32 s27, s27, 8388608
    v_pk_mul_f32 v[168:169], v[168:169], v[132:133]
    v_pk_mul_f32 v[170:171], v[170:171], v[134:135]
    v_pk_mul_f32 v[172:173], v[172:173], v[140:141]
    v_pk_mul_f32 v[174:175], v[174:175], v[142:143]
    v_pk_mul_f32 v[176:177], v[176:177], v[148:149]
    v_pk_mul_f32 v[178:179], v[178:179], v[150:151]
    v_cvt_pk_bf16_f32 v208, v168, v169
    v_cvt_pk_bf16_f32 v209, v170, v171
    v_cvt_pk_bf16_f32 v210, v172, v173
    v_cvt_pk_bf16_f32 v211, v174, v175
    v_cvt_pk_bf16_f32 v212, v176, v177
    v_cvt_pk_bf16_f32 v213, v178, v179
    buffer_store_dwordx4 v[208:211], v4, s[28:31], s27 offen
    buffer_store_dwordx2 v[212:213], v5, s[28:31], s27 offen
    s_endpgm
L_k2_ld:
    s_sub_u32 s18, s18, 4
    v_lshrrev_b32 v3, 4, v1
    v_and_b32 v4, 15, v1
    s_lshl_b32 s19, s18, 3
    s_lshl_b32 s24, s16, 8
    s_add_u32 s24, s24, 5242880
    s_lshl_b32 s26, s18, 11
    s_mul_i32 s27, s18, 3072
    s_mul_i32 s25, s17, 245760
    s_add_u32 s25, s25, s27
    s_add_u32 s25, s25, 18874368
    s_add_u32 s27, s27, 8192
    v_lshlrev_b32 v12, 4, v1
    v_add_u32 v5, 0, v3
    v_lshlrev_b32 v6, 1, v5
    v_xor_b32 v6, v6, v4
    v_add_u32 v5, s19, v5
    v_lshlrev_b32 v7, 12, v5
    v_lshl_add_u32 v10, v6, 4, v7
    v_add_u32 v5, 4, v3
    v_lshlrev_b32 v6, 1, v5
    v_xor_b32 v6, v6, v4
    v_add_u32 v5, s19, v5
    v_lshlrev_b32 v7, 12, v5
    v_lshl_add_u32 v11, v6, 4, v7
    s_waitcnt lgkmcnt(0)
    s_mov_b32 s28, s12
    s_mov_b32 s29, s13
    s_mov_b32 s30, 23068672
    s_mov_b32 s31, 0x00020000
    s_add_u32 m0, s26, 0
    s_add_u32 s32, s24, 0
    buffer_load_dwordx4 v10, s[28:31], s32 offen lds
    s_add_u32 m0, s26, 1024
    s_add_u32 s32, s24, 0
    buffer_load_dwordx4 v11, s[28:31], s32 offen lds
    s_add_u32 m0, s27, 0
    s_add_u32 s32, s25, 0
    buffer_load_dwordx4 v12, s[28:31], s32 offen offset:0 lds
    s_add_u32 m0, s27, 0
    s_add_u32 s32, s25, 0
    buffer_load_dwordx4 v12, s[28:31], s32 offen offset:1024 lds
    s_add_u32 m0, s27, 0
    s_add_u32 s32, s25, 0
    buffer_load_dwordx4 v12, s[28:31], s32 offen offset:2048 lds
    s_add_u32 m0, s26, 20480
    s_add_u32 s32, s24, 131072
    buffer_load_dwordx4 v10, s[28:31], s32 offen lds
    s_add_u32 m0, s26, 21504
    s_add_u32 s32, s24, 131072
    buffer_load_dwordx4 v11, s[28:31], s32 offen lds
    s_add_u32 m0, s27, 20480
    s_add_u32 s32, s25, 12288
    buffer_load_dwordx4 v12, s[28:31], s32 offen offset:0 lds
    s_add_u32 m0, s27, 20480
    s_add_u32 s32, s25, 12288
    buffer_load_dwordx4 v12, s[28:31], s32 offen offset:1024 lds
    s_add_u32 m0, s27, 20480
    s_add_u32 s32, s25, 12288
    buffer_load_dwordx4 v12, s[28:31], s32 offen offset:2048 lds
    s_waitcnt vmcnt(5)
    s_barrier
    s_add_u32 m0, s26, 40960
    s_add_u32 s32, s24, 262144
    buffer_load_dwordx4 v10, s[28:31], s32 offen lds
    s_add_u32 m0, s26, 41984
    s_add_u32 s32, s24, 262144
    buffer_load_dwordx4 v11, s[28:31], s32 offen lds
    s_add_u32 m0, s27, 40960
    s_add_u32 s32, s25, 24576
    buffer_load_dwordx4 v12, s[28:31], s32 offen offset:0 lds
    s_add_u32 m0, s27, 40960
    s_add_u32 s32, s25, 24576
    buffer_load_dwordx4 v12, s[28:31], s32 offen offset:1024 lds
    s_add_u32 m0, s27, 40960
    s_add_u32 s32, s25, 24576
    buffer_load_dwordx4 v12, s[28:31], s32 offen offset:2048 lds
    s_add_u32 m0, s26, 61440
    s_add_u32 s32, s24, 393216
    buffer_load_dwordx4 v10, s[28:31], s32 offen lds
    s_waitcnt vmcnt(6)
    s_barrier
    s_add_u32 m0, s26, 62464
    s_add_u32 s32, s24, 393216
    buffer_load_dwordx4 v11, s[28:31], s32 offen lds
    s_add_u32 m0, s27, 61440
    s_add_u32 s32, s25, 36864
    buffer_load_dwordx4 v12, s[28:31], s32 offen offset:0 lds
    s_add_u32 m0, s27, 61440
    s_add_u32 s32, s25, 36864
    buffer_load_dwordx4 v12, s[28:31], s32 offen offset:1024 lds
    s_add_u32 m0, s27, 61440
    s_add_u32 s32, s25, 36864
    buffer_load_dwordx4 v12, s[28:31], s32 offen offset:2048 lds
    s_add_u32 m0, s26, 81920
    s_add_u32 s32, s24, 524288
    buffer_load_dwordx4 v10, s[28:31], s32 offen lds
    s_add_u32 m0, s26, 82944
    s_add_u32 s32, s24, 524288
    buffer_load_dwordx4 v11, s[28:31], s32 offen lds
    s_waitcnt vmcnt(7)
    s_barrier
    s_add_u32 m0, s27, 81920
    s_add_u32 s32, s25, 49152
    buffer_load_dwordx4 v12, s[28:31], s32 offen offset:0 lds
    s_add_u32 m0, s27, 81920
    s_add_u32 s32, s25, 49152
    buffer_load_dwordx4 v12, s[28:31], s32 offen offset:1024 lds
    s_add_u32 m0, s27, 81920
    s_add_u32 s32, s25, 49152
    buffer_load_dwordx4 v12, s[28:31], s32 offen offset:2048 lds
    s_add_u32 m0, s26, 102400
    s_add_u32 s32, s24, 655360
    buffer_load_dwordx4 v10, s[28:31], s32 offen lds
    s_add_u32 m0, s26, 103424
    s_add_u32 s32, s24, 655360
    buffer_load_dwordx4 v11, s[28:31], s32 offen lds
    s_add_u32 m0, s27, 102400
    s_add_u32 s32, s25, 61440
    buffer_load_dwordx4 v12, s[28:31], s32 offen offset:0 lds
    s_waitcnt vmcnt(8)
    s_barrier
    s_add_u32 m0, s27, 102400
    s_add_u32 s32, s25, 61440
    buffer_load_dwordx4 v12, s[28:31], s32 offen offset:1024 lds
    s_add_u32 m0, s27, 102400
    s_add_u32 s32, s25, 61440
    buffer_load_dwordx4 v12, s[28:31], s32 offen offset:2048 lds
    s_add_u32 m0, s26, 122880
    s_add_u32 s32, s24, 786432
    buffer_load_dwordx4 v10, s[28:31], s32 offen lds
    s_add_u32 m0, s26, 123904
    s_add_u32 s32, s24, 786432
    buffer_load_dwordx4 v11, s[28:31], s32 offen lds
    s_add_u32 m0, s27, 122880
    s_add_u32 s32, s25, 73728
    buffer_load_dwordx4 v12, s[28:31], s32 offen offset:0 lds
    s_add_u32 m0, s27, 122880
    s_add_u32 s32, s25, 73728
    buffer_load_dwordx4 v12, s[28:31], s32 offen offset:1024 lds
    s_waitcnt vmcnt(9)
    s_barrier
    s_add_u32 m0, s27, 122880
    s_add_u32 s32, s25, 73728
    buffer_load_dwordx4 v12, s[28:31], s32 offen offset:2048 lds
    s_add_u32 m0, s26, 0
    s_add_u32 s32, s24, 917504
    buffer_load_dwordx4 v10, s[28:31], s32 offen lds
    s_add_u32 m0, s26, 1024
    s_add_u32 s32, s24, 917504
    buffer_load_dwordx4 v11, s[28:31], s32 offen lds
    s_add_u32 m0, s27, 0
    s_add_u32 s32, s25, 86016
    buffer_load_dwordx4 v12, s[28:31], s32 offen offset:0 lds
    s_add_u32 m0, s27, 0
    s_add_u32 s32, s25, 86016
    buffer_load_dwordx4 v12, s[28:31], s32 offen offset:1024 lds
    s_add_u32 m0, s27, 0
    s_add_u32 s32, s25, 86016
    buffer_load_dwordx4 v12, s[28:31], s32 offen offset:2048 lds
    s_waitcnt vmcnt(10)
    s_barrier
    s_add_u32 m0, s26, 20480
    s_add_u32 s32, s24, 1048576
    buffer_load_dwordx4 v10, s[28:31], s32 offen lds
    s_add_u32 m0, s26, 21504
    s_add_u32 s32, s24, 1048576
    buffer_load_dwordx4 v11, s[28:31], s32 offen lds
    s_add_u32 m0, s27, 20480
    s_add_u32 s32, s25, 98304
    buffer_load_dwordx4 v12, s[28:31], s32 offen offset:0 lds
    s_add_u32 m0, s27, 20480
    s_add_u32 s32, s25, 98304
    buffer_load_dwordx4 v12, s[28:31], s32 offen offset:1024 lds
    s_add_u32 m0, s27, 20480
    s_add_u32 s32, s25, 98304
    buffer_load_dwordx4 v12, s[28:31], s32 offen offset:2048 lds
    s_add_u32 m0, s26, 40960
    s_add_u32 s32, s24, 1179648
    buffer_load_dwordx4 v10, s[28:31], s32 offen lds
    s_waitcnt vmcnt(11)
    s_barrier
    s_add_u32 m0, s26, 41984
    s_add_u32 s32, s24, 1179648
    buffer_load_dwordx4 v11, s[28:31], s32 offen lds
    s_add_u32 m0, s27, 40960
    s_add_u32 s32, s25, 110592
    buffer_load_dwordx4 v12, s[28:31], s32 offen offset:0 lds
    s_add_u32 m0, s27, 40960
    s_add_u32 s32, s25, 110592
    buffer_load_dwordx4 v12, s[28:31], s32 offen offset:1024 lds
    s_add_u32 m0, s27, 40960
    s_add_u32 s32, s25, 110592
    buffer_load_dwordx4 v12, s[28:31], s32 offen offset:2048 lds
    s_add_u32 m0, s26, 61440
    s_add_u32 s32, s24, 1310720
    buffer_load_dwordx4 v10, s[28:31], s32 offen lds
    s_add_u32 m0, s26, 62464
    s_add_u32 s32, s24, 1310720
    buffer_load_dwordx4 v11, s[28:31], s32 offen lds
    s_waitcnt vmcnt(12)
    s_barrier
    s_add_u32 m0, s27, 61440
    s_add_u32 s32, s25, 122880
    buffer_load_dwordx4 v12, s[28:31], s32 offen offset:0 lds
    s_add_u32 m0, s27, 61440
    s_add_u32 s32, s25, 122880
    buffer_load_dwordx4 v12, s[28:31], s32 offen offset:1024 lds
    s_add_u32 m0, s27, 61440
    s_add_u32 s32, s25, 122880
    buffer_load_dwordx4 v12, s[28:31], s32 offen offset:2048 lds
    s_add_u32 m0, s26, 81920
    s_add_u32 s32, s24, 1441792
    buffer_load_dwordx4 v10, s[28:31], s32 offen lds
    s_add_u32 m0, s26, 82944
    s_add_u32 s32, s24, 1441792
    buffer_load_dwordx4 v11, s[28:31], s32 offen lds
    s_add_u32 m0, s27, 81920
    s_add_u32 s32, s25, 135168
    buffer_load_dwordx4 v12, s[28:31], s32 offen offset:0 lds
    s_waitcnt vmcnt(13)
    s_barrier
    s_add_u32 m0, s27, 81920
    s_add_u32 s32, s25, 135168
    buffer_load_dwordx4 v12, s[28:31], s32 offen offset:1024 lds
    s_add_u32 m0, s27, 81920
    s_add_u32 s32, s25, 135168
    buffer_load_dwordx4 v12, s[28:31], s32 offen offset:2048 lds
    s_add_u32 m0, s26, 102400
    s_add_u32 s32, s24, 1572864
    buffer_load_dwordx4 v10, s[28:31], s32 offen lds
    s_add_u32 m0, s26, 103424
    s_add_u32 s32, s24, 1572864
    buffer_load_dwordx4 v11, s[28:31], s32 offen lds
    s_add_u32 m0, s27, 102400
    s_add_u32 s32, s25, 147456
    buffer_load_dwordx4 v12, s[28:31], s32 offen offset:0 lds
    s_add_u32 m0, s27, 102400
    s_add_u32 s32, s25, 147456
    buffer_load_dwordx4 v12, s[28:31], s32 offen offset:1024 lds
    s_waitcnt vmcnt(14)
    s_barrier
    s_add_u32 m0, s27, 102400
    s_add_u32 s32, s25, 147456
    buffer_load_dwordx4 v12, s[28:31], s32 offen offset:2048 lds
    s_add_u32 m0, s26, 122880
    s_add_u32 s32, s24, 1703936
    buffer_load_dwordx4 v10, s[28:31], s32 offen lds
    s_add_u32 m0, s26, 123904
    s_add_u32 s32, s24, 1703936
    buffer_load_dwordx4 v11, s[28:31], s32 offen lds
    s_add_u32 m0, s27, 122880
    s_add_u32 s32, s25, 159744
    buffer_load_dwordx4 v12, s[28:31], s32 offen offset:0 lds
    s_add_u32 m0, s27, 122880
    s_add_u32 s32, s25, 159744
    buffer_load_dwordx4 v12, s[28:31], s32 offen offset:1024 lds
    s_add_u32 m0, s27, 122880
    s_add_u32 s32, s25, 159744
    buffer_load_dwordx4 v12, s[28:31], s32 offen offset:2048 lds
    s_waitcnt vmcnt(15)
    s_barrier
    s_add_u32 m0, s26, 0
    s_add_u32 s32, s24, 1835008
    buffer_load_dwordx4 v10, s[28:31], s32 offen lds
    s_add_u32 m0, s26, 1024
    s_add_u32 s32, s24, 1835008
    buffer_load_dwordx4 v11, s[28:31], s32 offen lds
    s_add_u32 m0, s27, 0
    s_add_u32 s32, s25, 172032
    buffer_load_dwordx4 v12, s[28:31], s32 offen offset:0 lds
    s_add_u32 m0, s27, 0
    s_add_u32 s32, s25, 172032
    buffer_load_dwordx4 v12, s[28:31], s32 offen offset:1024 lds
    s_add_u32 m0, s27, 0
    s_add_u32 s32, s25, 172032
    buffer_load_dwordx4 v12, s[28:31], s32 offen offset:2048 lds
    s_add_u32 m0, s26, 20480
    s_add_u32 s32, s24, 1966080
    buffer_load_dwordx4 v10, s[28:31], s32 offen lds
    s_waitcnt vmcnt(16)
    s_barrier
    s_add_u32 m0, s26, 21504
    s_add_u32 s32, s24, 1966080
    buffer_load_dwordx4 v11, s[28:31], s32 offen lds
    s_add_u32 m0, s27, 20480
    s_add_u32 s32, s25, 184320
    buffer_load_dwordx4 v12, s[28:31], s32 offen offset:0 lds
    s_add_u32 m0, s27, 20480
    s_add_u32 s32, s25, 184320
    buffer_load_dwordx4 v12, s[28:31], s32 offen offset:1024 lds
    s_add_u32 m0, s27, 20480
    s_add_u32 s32, s25, 184320
    buffer_load_dwordx4 v12, s[28:31], s32 offen offset:2048 lds
    s_add_u32 m0, s26, 40960
    s_add_u32 s32, s24, 2097152
    buffer_load_dwordx4 v10, s[28:31], s32 offen lds
    s_add_u32 m0, s26, 41984
    s_add_u32 s32, s24, 2097152
    buffer_load_dwordx4 v11, s[28:31], s32 offen lds
    s_waitcnt vmcnt(17)
    s_barrier
    s_add_u32 m0, s27, 40960
    s_add_u32 s32, s25, 196608
    buffer_load_dwordx4 v12, s[28:31], s32 offen offset:0 lds
    s_add_u32 m0, s27, 40960
    s_add_u32 s32, s25, 196608
    buffer_load_dwordx4 v12, s[28:31], s32 offen offset:1024 lds
    s_add_u32 m0, s27, 40960
    s_add_u32 s32, s25, 196608
    buffer_load_dwordx4 v12, s[28:31], s32 offen offset:2048 lds
    s_add_u32 m0, s26, 61440
    s_add_u32 s32, s24, 2228224
    buffer_load_dwordx4 v10, s[28:31], s32 offen lds
    s_add_u32 m0, s26, 62464
    s_add_u32 s32, s24, 2228224
    buffer_load_dwordx4 v11, s[28:31], s32 offen lds
    s_add_u32 m0, s27, 61440
    s_add_u32 s32, s25, 208896
    buffer_load_dwordx4 v12, s[28:31], s32 offen offset:0 lds
    s_waitcnt vmcnt(18)
    s_barrier
    s_add_u32 m0, s27, 61440
    s_add_u32 s32, s25, 208896
    buffer_load_dwordx4 v12, s[28:31], s32 offen offset:1024 lds
    s_add_u32 m0, s27, 61440
    s_add_u32 s32, s25, 208896
    buffer_load_dwordx4 v12, s[28:31], s32 offen offset:2048 lds
    s_add_u32 m0, s26, 81920
    s_add_u32 s32, s24, 2359296
    buffer_load_dwordx4 v10, s[28:31], s32 offen lds
    s_add_u32 m0, s26, 82944
    s_add_u32 s32, s24, 2359296
    buffer_load_dwordx4 v11, s[28:31], s32 offen lds
    s_add_u32 m0, s27, 81920
    s_add_u32 s32, s25, 221184
    buffer_load_dwordx4 v12, s[28:31], s32 offen offset:0 lds
    s_add_u32 m0, s27, 81920
    s_add_u32 s32, s25, 221184
    buffer_load_dwordx4 v12, s[28:31], s32 offen offset:1024 lds
    s_waitcnt vmcnt(19)
    s_barrier
    s_add_u32 m0, s27, 81920
    s_add_u32 s32, s25, 221184
    buffer_load_dwordx4 v12, s[28:31], s32 offen offset:2048 lds
    s_add_u32 m0, s26, 102400
    s_add_u32 s32, s24, 2490368
    buffer_load_dwordx4 v10, s[28:31], s32 offen lds
    s_add_u32 m0, s26, 103424
    s_add_u32 s32, s24, 2490368
    buffer_load_dwordx4 v11, s[28:31], s32 offen lds
    s_add_u32 m0, s27, 102400
    s_add_u32 s32, s25, 233472
    buffer_load_dwordx4 v12, s[28:31], s32 offen offset:0 lds
    s_add_u32 m0, s27, 102400
    s_add_u32 s32, s25, 233472
    buffer_load_dwordx4 v12, s[28:31], s32 offen offset:1024 lds
    s_add_u32 m0, s27, 102400
    s_add_u32 s32, s25, 233472
    buffer_load_dwordx4 v12, s[28:31], s32 offen offset:2048 lds
    s_waitcnt vmcnt(20)
    s_barrier
    s_waitcnt vmcnt(15)
    s_barrier
    s_waitcnt vmcnt(10)
    s_barrier
    s_waitcnt vmcnt(5)
    s_barrier
    s_waitcnt vmcnt(0)
    s_barrier
    s_barrier
L_k2_end:
    s_endpgm
.p2align 8
.globl k3_kernel
.type k3_kernel,@function
k3_kernel:
    s_cmp_ge_u32 s2, 256
    s_cbranch_scc1 L_k3_end
    s_load_dwordx2 s[10:11], s[0:1], 80
    s_load_dwordx2 s[12:13], s[0:1], 96
    s_and_b32 s14, s2, 7
    s_lshr_b32 s15, s2, 3
    s_and_b32 s16, s14, 3
    s_lshl_b32 s16, s16, 3
    s_and_b32 s17, s15, 7
    s_add_u32 s16, s16, s17
    s_lshr_b32 s17, s14, 2
    s_lshl_b32 s17, s17, 2
    s_lshr_b32 s15, s15, 3
    s_add_u32 s17, s17, s15
    v_lshrrev_b32 v2, 6, v0
    v_and_b32 v1, 63, v0
    v_lshlrev_b32 v3, 4, v1
    v_readfirstlane_b32 s18, v2
    s_cmp_ge_u32 s18, 4
    s_cbranch_scc1 L_k3_ld
    s_lshl_b32 s26, s16, 2
    s_add_u32 s26, s26, s18
    s_mul_i32 s24, s26, 49152
    s_add_u32 s24, s24, 8388608
    v_add_u32 v4, 61440, v3
    v_add_u32 v5, 122880, v3
    s_waitcnt lgkmcnt(0)
    s_mov_b32 s28, s12
    s_mov_b32 s29, s13
    s_mov_b32 s30, 16777216
    s_mov_b32 s31, 0x00020000
    s_mov_b32 s40, s10
    s_mov_b32 s41, s11
    s_mov_b32 s42, 2621440
    s_mov_b32 s43, 0x00020000
    buffer_load_dwordx4 v[192:195], v3, s[28:31], s24 offen offset:0
    buffer_load_dwordx4 v[196:199], v3, s[28:31], s24 offen offset:1024
    buffer_load_dwordx4 v[200:203], v3, s[28:31], s24 offen offset:2048
    buffer_load_dwordx4 v[204:207], v3, s[28:31], s24 offen offset:3072
    s_add_u32 s24, s24, 4096
    buffer_load_dwordx4 v[208:211], v3, s[28:31], s24 offen offset:0
    buffer_load_dwordx4 v[212:215], v3, s[28:31], s24 offen offset:1024
    buffer_load_dwordx4 v[216:219], v3, s[28:31], s24 offen offset:2048
    buffer_load_dwordx4 v[220:223], v3, s[28:31], s24 offen offset:3072
    s_add_u32 s24, s24, 4096
    buffer_load_dwordx4 v[224:227], v3, s[28:31], s24 offen offset:0
    buffer_load_dwordx4 v[228:231], v3, s[28:31], s24 offen offset:1024
    buffer_load_dwordx4 v[232:235], v3, s[28:31], s24 offen offset:2048
    buffer_load_dwordx4 v[236:239], v3, s[28:31], s24 offen offset:3072
    s_add_u32 s24, s24, 4096
    v_lshrrev_b32 v7, 2, v1
    v_and_b32 v8, 3, v1
    v_lshlrev_b32 v8, 3, v8
    v_lshl_add_u32 v8, v7, 5, v8
    s_mul_i32 s44, s18, 3072
    s_add_u32 s44, s44, 143360
    v_add_u32 v8, s44, v8
    v_lshrrev_b32 v7, 1, v1
    v_lshlrev_b32 v7, 12, v7
    v_and_b32 v9, 1, v1
    v_lshl_add_u32 v7, v9, 4, v7
    s_mul_i32 s45, s17, 327680
    s_lshl_b32 s46, s26, 5
    s_add_u32 s45, s45, s46
    s_add_u32 s45, s45, 5242880
    s_mul_i32 s25, s17, 160
    v_and_b32 v6, 15, v1
    s_lshl_b32 s46, s26, 4
    v_add_u32 v6, s46, v6
    v_mul_u32_u24 v6, 1280, v6
    v_lshrrev_b32 v9, 4, v1
    v_lshl_add_u32 v6, v9, 3, v6
    s_setprio 2
    s_barrier
    ds_read_b128 v[32:35], v3 offset:0
    ds_read_b128 v[36:39], v3 offset:1024
    ds_read_b128 v[40:43], v3 offset:2048
    ds_read_b128 v[44:47], v3 offset:3072
    ds_read_b128 v[48:51], v3 offset:4096
    ds_read_b128 v[52:55], v3 offset:5120
    ds_read_b128 v[56:59], v3 offset:6144
    ds_read_b128 v[60:63], v3 offset:7168
    ds_read_b128 v[64:67], v3 offset:8192
    ds_read_b128 v[68:71], v3 offset:9216
    ds_read_b128 v[72:75], v3 offset:10240
    ds_read_b128 v[76:79], v3 offset:11264
    ds_read_b128 v[80:83], v3 offset:12288
    ds_read_b128 v[84:87], v3 offset:13312
    ds_read_b128 v[88:91], v3 offset:14336
    ds_read_b128 v[92:95], v3 offset:15360
    ds_read_b128 v[96:99], v3 offset:16384
    ds_read_b128 v[100:103], v3 offset:17408
    ds_read_b128 v[104:107], v3 offset:18432
    ds_read_b128 v[108:111], v3 offset:19456
    s_waitcnt lgkmcnt(0)
    s_barrier
    s_waitcnt vmcnt(8)
    buffer_load_dwordx4 v[240:243], v3, s[28:31], s24 offen offset:0
    buffer_load_dwordx4 v[244:247], v3, s[28:31], s24 offen offset:1024
    buffer_load_dwordx4 v[248:251], v3, s[28:31], s24 offen offset:2048
    buffer_load_dwordx4 v[252:255], v3, s[28:31], s24 offen offset:3072
    s_add_u32 s24, s24, 4096
    v_mfma_f32_16x16x32_bf16 v[12:15], v[32:35], v[192:195], 0
    ds_read_b128 v[112:115], v3 offset:20480
    v_mfma_f32_16x16x32_bf16 v[16:19], v[36:39], v[192:195], 0
    ds_read_b128 v[116:119], v3 offset:21504
    v_mfma_f32_16x16x32_bf16 v[20:23], v[40:43], v[192:195], 0
    ds_read_b128 v[120:123], v3 offset:22528
    v_mfma_f32_16x16x32_bf16 v[24:27], v[44:47], v[192:195], 0
    ds_read_b128 v[124:127], v3 offset:23552
    v_mfma_f32_16x16x32_bf16 v[28:31], v[48:51], v[192:195], 0
    ds_read_b128 v[128:131], v3 offset:24576
    v_mfma_f32_16x16x32_bf16 v[12:15], v[52:55], v[196:199], v[12:15]
    ds_read_b128 v[132:135], v3 offset:25600
    v_mfma_f32_16x16x32_bf16 v[16:19], v[56:59], v[196:199], v[16:19]
    ds_read_b128 v[136:139], v3 offset:26624
    v_mfma_f32_16x16x32_bf16 v[20:23], v[60:63], v[196:199], v[20:23]
    ds_read_b128 v[140:143], v3 offset:27648
    v_mfma_f32_16x16x32_bf16 v[24:27], v[64:67], v[196:199], v[24:27]
    ds_read_b128 v[144:147], v3 offset:28672
    v_mfma_f32_16x16x32_bf16 v[28:31], v[68:71], v[196:199], v[28:31]
    ds_read_b128 v[148:151], v3 offset:29696
    v_mfma_f32_16x16x32_bf16 v[12:15], v[72:75], v[200:203], v[12:15]
    ds_read_b128 v[152:155], v3 offset:30720
    v_mfma_f32_16x16x32_bf16 v[16:19], v[76:79], v[200:203], v[16:19]
    ds_read_b128 v[156:159], v3 offset:31744
    v_mfma_f32_16x16x32_bf16 v[20:23], v[80:83], v[200:203], v[20:23]
    ds_read_b128 v[160:163], v3 offset:32768
    v_mfma_f32_16x16x32_bf16 v[24:27], v[84:87], v[200:203], v[24:27]
    ds_read_b128 v[164:167], v3 offset:33792
    v_mfma_f32_16x16x32_bf16 v[28:31], v[88:91], v[200:203], v[28:31]
    ds_read_b128 v[168:171], v3 offset:34816
    v_mfma_f32_16x16x32_bf16 v[12:15], v[92:95], v[204:207], v[12:15]
    ds_read_b128 v[172:175], v3 offset:35840
    v_mfma_f32_16x16x32_bf16 v[16:19], v[96:99], v[204:207], v[16:19]
    ds_read_b128 v[176:179], v3 offset:36864
    v_mfma_f32_16x16x32_bf16 v[20:23], v[100:103], v[204:207], v[20:23]
    ds_read_b128 v[180:183], v3 offset:37888
    v_mfma_f32_16x16x32_bf16 v[24:27], v[104:107], v[204:207], v[24:27]
    ds_read_b128 v[184:187], v3 offset:38912
    v_mfma_f32_16x16x32_bf16 v[28:31], v[108:111], v[204:207], v[28:31]
    ds_read_b128 v[188:191], v3 offset:39936
    s_waitcnt lgkmcnt(0)
    s_barrier
    s_waitcnt vmcnt(8)
    buffer_load_dwordx4 v[192:195], v3, s[28:31], s24 offen offset:0
    buffer_load_dwordx4 v[196:199], v3, s[28:31], s24 offen offset:1024
    buffer_load_dwordx4 v[200:203], v3, s[28:31], s24 offen offset:2048
    buffer_load_dwordx4 v[204:207], v3, s[28:31], s24 offen offset:3072
    s_add_u32 s24, s24, 4096
    v_mfma_f32_16x16x32_bf16 v[12:15], v[112:115], v[208:211], v[12:15]
    ds_read_b128 v[32:35], v3 offset:40960
    v_mfma_f32_16x16x32_bf16 v[16:19], v[116:119], v[208:211], v[16:19]
    ds_read_b128 v[36:39], v3 offset:41984
    v_mfma_f32_16x16x32_bf16 v[20:23], v[120:123], v[208:211], v[20:23]
    ds_read_b128 v[40:43], v3 offset:43008
    v_mfma_f32_16x16x32_bf16 v[24:27], v[124:127], v[208:211], v[24:27]
    ds_read_b128 v[44:47], v3 offset:44032
    v_mfma_f32_16x16x32_bf16 v[28:31], v[128:131], v[208:211], v[28:31]
    ds_read_b128 v[48:51], v3 offset:45056
    v_mfma_f32_16x16x32_bf16 v[12:15], v[132:135], v[212:215], v[12:15]
    ds_read_b128 v[52:55], v3 offset:46080
    v_mfma_f32_16x16x32_bf16 v[16:19], v[136:139], v[212:215], v[16:19]
    ds_read_b128 v[56:59], v3 offset:47104
    v_mfma_f32_16x16x32_bf16 v[20:23], v[140:143], v[212:215], v[20:23]
    ds_read_b128 v[60:63], v3 offset:48128
    v_mfma_f32_16x16x32_bf16 v[24:27], v[144:147], v[212:215], v[24:27]
    ds_read_b128 v[64:67], v3 offset:49152
    v_mfma_f32_16x16x32_bf16 v[28:31], v[148:151], v[212:215], v[28:31]
    ds_read_b128 v[68:71], v3 offset:50176
    v_mfma_f32_16x16x32_bf16 v[12:15], v[152:155], v[216:219], v[12:15]
    ds_read_b128 v[72:75], v3 offset:51200
    v_mfma_f32_16x16x32_bf16 v[16:19], v[156:159], v[216:219], v[16:19]
    ds_read_b128 v[76:79], v3 offset:52224
    v_mfma_f32_16x16x32_bf16 v[20:23], v[160:163], v[216:219], v[20:23]
    ds_read_b128 v[80:83], v3 offset:53248
    v_mfma_f32_16x16x32_bf16 v[24:27], v[164:167], v[216:219], v[24:27]
    ds_read_b128 v[84:87], v3 offset:54272
    v_mfma_f32_16x16x32_bf16 v[28:31], v[168:171], v[216:219], v[28:31]
    ds_read_b128 v[88:91], v3 offset:55296
    v_mfma_f32_16x16x32_bf16 v[12:15], v[172:175], v[220:223], v[12:15]
    ds_read_b128 v[92:95], v3 offset:56320
    v_mfma_f32_16x16x32_bf16 v[16:19], v[176:179], v[220:223], v[16:19]
    ds_read_b128 v[96:99], v3 offset:57344
    v_mfma_f32_16x16x32_bf16 v[20:23], v[180:183], v[220:223], v[20:23]
    ds_read_b128 v[100:103], v3 offset:58368
    v_mfma_f32_16x16x32_bf16 v[24:27], v[184:187], v[220:223], v[24:27]
    ds_read_b128 v[104:107], v3 offset:59392
    v_mfma_f32_16x16x32_bf16 v[28:31], v[188:191], v[220:223], v[28:31]
    ds_read_b128 v[108:111], v3 offset:60416
    s_waitcnt lgkmcnt(0)
    s_barrier
    s_waitcnt vmcnt(8)
    buffer_load_dwordx4 v[208:211], v3, s[28:31], s24 offen offset:0
    buffer_load_dwordx4 v[212:215], v3, s[28:31], s24 offen offset:1024
    buffer_load_dwordx4 v[216:219], v3, s[28:31], s24 offen offset:2048
    buffer_load_dwordx4 v[220:223], v3, s[28:31], s24 offen offset:3072
    s_add_u32 s24, s24, 4096
    v_mfma_f32_16x16x32_bf16 v[12:15], v[32:35], v[224:227], v[12:15]
    ds_read_b128 v[112:115], v4 offset:0
    v_mfma_f32_16x16x32_bf16 v[16:19], v[36:39], v[224:227], v[16:19]
    ds_read_b128 v[116:119], v4 offset:1024
    v_mfma_f32_16x16x32_bf16 v[20:23], v[40:43], v[224:227], v[20:23]
    ds_read_b128 v[120:123], v4 offset:2048
    v_mfma_f32_16x16x32_bf16 v[24:27], v[44:47], v[224:227], v[24:27]
    ds_read_b128 v[124:127], v4 offset:3072
    v_mfma_f32_16x16x32_bf16 v[28:31], v[48:51], v[224:227], v[28:31]
    ds_read_b128 v[128:131], v4 offset:4096
    v_mfma_f32_16x16x32_bf16 v[12:15], v[52:55], v[228:231], v[12:15]
    ds_read_b128 v[132:135], v4 offset:5120
    v_mfma_f32_16x16x32_bf16 v[16:19], v[56:59], v[228:231], v[16:19]
    ds_read_b128 v[136:139], v4 offset:6144
    v_mfma_f32_16x16x32_bf16 v[20:23], v[60:63], v[228:231], v[20:23]
    ds_read_b128 v[140:143], v4 offset:7168
    v_mfma_f32_16x16x32_bf16 v[24:27], v[64:67], v[228:231], v[24:27]
    ds_read_b128 v[144:147], v4 offset:8192
    v_mfma_f32_16x16x32_bf16 v[28:31], v[68:71], v[228:231], v[28:31]
    ds_read_b128 v[148:151], v4 offset:9216
    v_mfma_f32_16x16x32_bf16 v[12:15], v[72:75], v[232:235], v[12:15]
    ds_read_b128 v[152:155], v4 offset:10240
    v_mfma_f32_16x16x32_bf16 v[16:19], v[76:79], v[232:235], v[16:19]
    ds_read_b128 v[156:159], v4 offset:11264
    v_mfma_f32_16x16x32_bf16 v[20:23], v[80:83], v[232:235], v[20:23]
    ds_read_b128 v[160:163], v4 offset:12288
    v_mfma_f32_16x16x32_bf16 v[24:27], v[84:87], v[232:235], v[24:27]
    ds_read_b128 v[164:167], v4 offset:13312
    v_mfma_f32_16x16x32_bf16 v[28:31], v[88:91], v[232:235], v[28:31]
    ds_read_b128 v[168:171], v4 offset:14336
    v_mfma_f32_16x16x32_bf16 v[12:15], v[92:95], v[236:239], v[12:15]
    ds_read_b128 v[172:175], v4 offset:15360
    v_mfma_f32_16x16x32_bf16 v[16:19], v[96:99], v[236:239], v[16:19]
    ds_read_b128 v[176:179], v4 offset:16384
    v_mfma_f32_16x16x32_bf16 v[20:23], v[100:103], v[236:239], v[20:23]
    ds_read_b128 v[180:183], v4 offset:17408
    v_mfma_f32_16x16x32_bf16 v[24:27], v[104:107], v[236:239], v[24:27]
    ds_read_b128 v[184:187], v4 offset:18432
    v_mfma_f32_16x16x32_bf16 v[28:31], v[108:111], v[236:239], v[28:31]
    ds_read_b128 v[188:191], v4 offset:19456
    s_waitcnt lgkmcnt(0)
    s_barrier
    s_waitcnt vmcnt(8)
    buffer_load_dwordx4 v[224:227], v3, s[28:31], s24 offen offset:0
    buffer_load_dwordx4 v[228:231], v3, s[28:31], s24 offen offset:1024
    buffer_load_dwordx4 v[232:235], v3, s[28:31], s24 offen offset:2048
    buffer_load_dwordx4 v[236:239], v3, s[28:31], s24 offen offset:3072
    s_add_u32 s24, s24, 4096
    v_mfma_f32_16x16x32_bf16 v[12:15], v[112:115], v[240:243], v[12:15]
    ds_read_b128 v[32:35], v4 offset:20480
    v_mfma_f32_16x16x32_bf16 v[16:19], v[116:119], v[240:243], v[16:19]
    ds_read_b128 v[36:39], v4 offset:21504
    v_mfma_f32_16x16x32_bf16 v[20:23], v[120:123], v[240:243], v[20:23]
    ds_read_b128 v[40:43], v4 offset:22528
    v_mfma_f32_16x16x32_bf16 v[24:27], v[124:127], v[240:243], v[24:27]
    ds_read_b128 v[44:47], v4 offset:23552
    v_mfma_f32_16x16x32_bf16 v[28:31], v[128:131], v[240:243], v[28:31]
    ds_read_b128 v[48:51], v4 offset:24576
    v_mfma_f32_16x16x32_bf16 v[12:15], v[132:135], v[244:247], v[12:15]
    ds_read_b128 v[52:55], v4 offset:25600
    v_mfma_f32_16x16x32_bf16 v[16:19], v[136:139], v[244:247], v[16:19]
    ds_read_b128 v[56:59], v4 offset:26624
    v_mfma_f32_16x16x32_bf16 v[20:23], v[140:143], v[244:247], v[20:23]
    ds_read_b128 v[60:63], v4 offset:27648
    v_mfma_f32_16x16x32_bf16 v[24:27], v[144:147], v[244:247], v[24:27]
    ds_read_b128 v[64:67], v4 offset:28672
    v_mfma_f32_16x16x32_bf16 v[28:31], v[148:151], v[244:247], v[28:31]
    ds_read_b128 v[68:71], v4 offset:29696
    v_mfma_f32_16x16x32_bf16 v[12:15], v[152:155], v[248:251], v[12:15]
    ds_read_b128 v[72:75], v4 offset:30720
    v_mfma_f32_16x16x32_bf16 v[16:19], v[156:159], v[248:251], v[16:19]
    ds_read_b128 v[76:79], v4 offset:31744
    v_mfma_f32_16x16x32_bf16 v[20:23], v[160:163], v[248:251], v[20:23]
    ds_read_b128 v[80:83], v4 offset:32768
    v_mfma_f32_16x16x32_bf16 v[24:27], v[164:167], v[248:251], v[24:27]
    ds_read_b128 v[84:87], v4 offset:33792
    v_mfma_f32_16x16x32_bf16 v[28:31], v[168:171], v[248:251], v[28:31]
    ds_read_b128 v[88:91], v4 offset:34816
    v_mfma_f32_16x16x32_bf16 v[12:15], v[172:175], v[252:255], v[12:15]
    ds_read_b128 v[92:95], v4 offset:35840
    v_mfma_f32_16x16x32_bf16 v[16:19], v[176:179], v[252:255], v[16:19]
    ds_read_b128 v[96:99], v4 offset:36864
    v_mfma_f32_16x16x32_bf16 v[20:23], v[180:183], v[252:255], v[20:23]
    ds_read_b128 v[100:103], v4 offset:37888
    v_mfma_f32_16x16x32_bf16 v[24:27], v[184:187], v[252:255], v[24:27]
    ds_read_b128 v[104:107], v4 offset:38912
    v_mfma_f32_16x16x32_bf16 v[28:31], v[188:191], v[252:255], v[28:31]
    ds_read_b128 v[108:111], v4 offset:39936
    s_waitcnt lgkmcnt(0)
    s_barrier
    s_waitcnt vmcnt(8)
    buffer_load_dwordx4 v[240:243], v3, s[28:31], s24 offen offset:0
    buffer_load_dwordx4 v[244:247], v3, s[28:31], s24 offen offset:1024
    buffer_load_dwordx4 v[248:251], v3, s[28:31], s24 offen offset:2048
    buffer_load_dwordx4 v[252:255], v3, s[28:31], s24 offen offset:3072
    s_add_u32 s24, s24, 4096
    v_mfma_f32_16x16x32_bf16 v[12:15], v[32:35], v[192:195], v[12:15]
    ds_read_b128 v[112:115], v4 offset:40960
    v_mfma_f32_16x16x32_bf16 v[16:19], v[36:39], v[192:195], v[16:19]
    ds_read_b128 v[116:119], v4 offset:41984
    v_mfma_f32_16x16x32_bf16 v[20:23], v[40:43], v[192:195], v[20:23]
    ds_read_b128 v[120:123], v4 offset:43008
    v_mfma_f32_16x16x32_bf16 v[24:27], v[44:47], v[192:195], v[24:27]
    ds_read_b128 v[124:127], v4 offset:44032
    v_mfma_f32_16x16x32_bf16 v[28:31], v[48:51], v[192:195], v[28:31]
    ds_read_b128 v[128:131], v4 offset:45056
    v_mfma_f32_16x16x32_bf16 v[12:15], v[52:55], v[196:199], v[12:15]
    ds_read_b128 v[132:135], v4 offset:46080
    v_mfma_f32_16x16x32_bf16 v[16:19], v[56:59], v[196:199], v[16:19]
    ds_read_b128 v[136:139], v4 offset:47104
    v_mfma_f32_16x16x32_bf16 v[20:23], v[60:63], v[196:199], v[20:23]
    ds_read_b128 v[140:143], v4 offset:48128
    v_mfma_f32_16x16x32_bf16 v[24:27], v[64:67], v[196:199], v[24:27]
    ds_read_b128 v[144:147], v4 offset:49152
    v_mfma_f32_16x16x32_bf16 v[28:31], v[68:71], v[196:199], v[28:31]
    ds_read_b128 v[148:151], v4 offset:50176
    v_mfma_f32_16x16x32_bf16 v[12:15], v[72:75], v[200:203], v[12:15]
    ds_read_b128 v[152:155], v4 offset:51200
    v_mfma_f32_16x16x32_bf16 v[16:19], v[76:79], v[200:203], v[16:19]
    ds_read_b128 v[156:159], v4 offset:52224
    v_mfma_f32_16x16x32_bf16 v[20:23], v[80:83], v[200:203], v[20:23]
    ds_read_b128 v[160:163], v4 offset:53248
    v_mfma_f32_16x16x32_bf16 v[24:27], v[84:87], v[200:203], v[24:27]
    ds_read_b128 v[164:167], v4 offset:54272
    v_mfma_f32_16x16x32_bf16 v[28:31], v[88:91], v[200:203], v[28:31]
    ds_read_b128 v[168:171], v4 offset:55296
    v_mfma_f32_16x16x32_bf16 v[12:15], v[92:95], v[204:207], v[12:15]
    ds_read_b128 v[172:175], v4 offset:56320
    v_mfma_f32_16x16x32_bf16 v[16:19], v[96:99], v[204:207], v[16:19]
    ds_read_b128 v[176:179], v4 offset:57344
    v_mfma_f32_16x16x32_bf16 v[20:23], v[100:103], v[204:207], v[20:23]
    ds_read_b128 v[180:183], v4 offset:58368
    v_mfma_f32_16x16x32_bf16 v[24:27], v[104:107], v[204:207], v[24:27]
    ds_read_b128 v[184:187], v4 offset:59392
    v_mfma_f32_16x16x32_bf16 v[28:31], v[108:111], v[204:207], v[28:31]
    ds_read_b128 v[188:191], v4 offset:60416
    s_waitcnt lgkmcnt(0)
    s_barrier
    s_waitcnt vmcnt(8)
    buffer_load_dwordx4 v[192:195], v3, s[28:31], s24 offen offset:0
    buffer_load_dwordx4 v[196:199], v3, s[28:31], s24 offen offset:1024
    buffer_load_dwordx4 v[200:203], v3, s[28:31], s24 offen offset:2048
    buffer_load_dwordx4 v[204:207], v3, s[28:31], s24 offen offset:3072
    s_add_u32 s24, s24, 4096
    v_mfma_f32_16x16x32_bf16 v[12:15], v[112:115], v[208:211], v[12:15]
    ds_read_b128 v[32:35], v5 offset:0
    v_mfma_f32_16x16x32_bf16 v[16:19], v[116:119], v[208:211], v[16:19]
    ds_read_b128 v[36:39], v5 offset:1024
    v_mfma_f32_16x16x32_bf16 v[20:23], v[120:123], v[208:211], v[20:23]
    ds_read_b128 v[40:43], v5 offset:2048
    v_mfma_f32_16x16x32_bf16 v[24:27], v[124:127], v[208:211], v[24:27]
    ds_read_b128 v[44:47], v5 offset:3072
    v_mfma_f32_16x16x32_bf16 v[28:31], v[128:131], v[208:211], v[28:31]
    ds_read_b128 v[48:51], v5 offset:4096
    v_mfma_f32_16x16x32_bf16 v[12:15], v[132:135], v[212:215], v[12:15]
    ds_read_b128 v[52:55], v5 offset:5120
    v_mfma_f32_16x16x32_bf16 v[16:19], v[136:139], v[212:215], v[16:19]
    ds_read_b128 v[56:59], v5 offset:6144
    v_mfma_f32_16x16x32_bf16 v[20:23], v[140:143], v[212:215], v[20:23]
    ds_read_b128 v[60:63], v5 offset:7168
    v_mfma_f32_16x16x32_bf16 v[24:27], v[144:147], v[212:215], v[24:27]
    ds_read_b128 v[64:67], v5 offset:8192
    v_mfma_f32_16x16x32_bf16 v[28:31], v[148:151], v[212:215], v[28:31]
    ds_read_b128 v[68:71], v5 offset:9216
    v_mfma_f32_16x16x32_bf16 v[12:15], v[152:155], v[216:219], v[12:15]
    ds_read_b128 v[72:75], v5 offset:10240
    v_mfma_f32_16x16x32_bf16 v[16:19], v[156:159], v[216:219], v[16:19]
    ds_read_b128 v[76:79], v5 offset:11264
    v_mfma_f32_16x16x32_bf16 v[20:23], v[160:163], v[216:219], v[20:23]
    ds_read_b128 v[80:83], v5 offset:12288
    v_mfma_f32_16x16x32_bf16 v[24:27], v[164:167], v[216:219], v[24:27]
    ds_read_b128 v[84:87], v5 offset:13312
    v_mfma_f32_16x16x32_bf16 v[28:31], v[168:171], v[216:219], v[28:31]
    ds_read_b128 v[88:91], v5 offset:14336
    v_mfma_f32_16x16x32_bf16 v[12:15], v[172:175], v[220:223], v[12:15]
    ds_read_b128 v[92:95], v5 offset:15360
    v_mfma_f32_16x16x32_bf16 v[16:19], v[176:179], v[220:223], v[16:19]
    ds_read_b128 v[96:99], v5 offset:16384
    v_mfma_f32_16x16x32_bf16 v[20:23], v[180:183], v[220:223], v[20:23]
    ds_read_b128 v[100:103], v5 offset:17408
    v_mfma_f32_16x16x32_bf16 v[24:27], v[184:187], v[220:223], v[24:27]
    ds_read_b128 v[104:107], v5 offset:18432
    v_mfma_f32_16x16x32_bf16 v[28:31], v[188:191], v[220:223], v[28:31]
    ds_read_b128 v[108:111], v5 offset:19456
    s_waitcnt lgkmcnt(0)
    s_barrier
    s_waitcnt vmcnt(8)
    buffer_load_dwordx4 v[208:211], v3, s[28:31], s24 offen offset:0
    buffer_load_dwordx4 v[212:215], v3, s[28:31], s24 offen offset:1024
    buffer_load_dwordx4 v[216:219], v3, s[28:31], s24 offen offset:2048
    buffer_load_dwordx4 v[220:223], v3, s[28:31], s24 offen offset:3072
    s_add_u32 s24, s24, 4096
    v_mfma_f32_16x16x32_bf16 v[12:15], v[32:35], v[224:227], v[12:15]
    ds_read_b128 v[112:115], v3 offset:0
    v_mfma_f32_16x16x32_bf16 v[16:19], v[36:39], v[224:227], v[16:19]
    ds_read_b128 v[116:119], v3 offset:1024
    v_mfma_f32_16x16x32_bf16 v[20:23], v[40:43], v[224:227], v[20:23]
    ds_read_b128 v[120:123], v3 offset:2048
    v_mfma_f32_16x16x32_bf16 v[24:27], v[44:47], v[224:227], v[24:27]
    ds_read_b128 v[124:127], v3 offset:3072
    v_mfma_f32_16x16x32_bf16 v[28:31], v[48:51], v[224:227], v[28:31]
    ds_read_b128 v[128:131], v3 offset:4096
    v_mfma_f32_16x16x32_bf16 v[12:15], v[52:55], v[228:231], v[12:15]
    ds_read_b128 v[132:135], v3 offset:5120
    v_mfma_f32_16x16x32_bf16 v[16:19], v[56:59], v[228:231], v[16:19]
    ds_read_b128 v[136:139], v3 offset:6144
    v_mfma_f32_16x16x32_bf16 v[20:23], v[60:63], v[228:231], v[20:23]
    ds_read_b128 v[140:143], v3 offset:7168
    v_mfma_f32_16x16x32_bf16 v[24:27], v[64:67], v[228:231], v[24:27]
    ds_read_b128 v[144:147], v3 offset:8192
    v_mfma_f32_16x16x32_bf16 v[28:31], v[68:71], v[228:231], v[28:31]
    ds_read_b128 v[148:151], v3 offset:9216
    v_mfma_f32_16x16x32_bf16 v[12:15], v[72:75], v[232:235], v[12:15]
    ds_read_b128 v[152:155], v3 offset:10240
    v_mfma_f32_16x16x32_bf16 v[16:19], v[76:79], v[232:235], v[16:19]
    ds_read_b128 v[156:159], v3 offset:11264
    v_mfma_f32_16x16x32_bf16 v[20:23], v[80:83], v[232:235], v[20:23]
    ds_read_b128 v[160:163], v3 offset:12288
    v_mfma_f32_16x16x32_bf16 v[24:27], v[84:87], v[232:235], v[24:27]
    ds_read_b128 v[164:167], v3 offset:13312
    v_mfma_f32_16x16x32_bf16 v[28:31], v[88:91], v[232:235], v[28:31]
    ds_read_b128 v[168:171], v3 offset:14336
    v_mfma_f32_16x16x32_bf16 v[12:15], v[92:95], v[236:239], v[12:15]
    ds_read_b128 v[172:175], v3 offset:15360
    v_mfma_f32_16x16x32_bf16 v[16:19], v[96:99], v[236:239], v[16:19]
    ds_read_b128 v[176:179], v3 offset:16384
    v_mfma_f32_16x16x32_bf16 v[20:23], v[100:103], v[236:239], v[20:23]
    ds_read_b128 v[180:183], v3 offset:17408
    v_mfma_f32_16x16x32_bf16 v[24:27], v[104:107], v[236:239], v[24:27]
    ds_read_b128 v[184:187], v3 offset:18432
    v_mfma_f32_16x16x32_bf16 v[28:31], v[108:111], v[236:239], v[28:31]
    ds_read_b128 v[188:191], v3 offset:19456
    s_waitcnt lgkmcnt(0)
    s_barrier
    s_waitcnt vmcnt(8)
    buffer_load_dwordx4 v[224:227], v3, s[28:31], s24 offen offset:0
    buffer_load_dwordx4 v[228:231], v3, s[28:31], s24 offen offset:1024
    buffer_load_dwordx4 v[232:235], v3, s[28:31], s24 offen offset:2048
    buffer_load_dwordx4 v[236:239], v3, s[28:31], s24 offen offset:3072
    s_add_u32 s24, s24, 4096
    s_add_u32 m0, s44, 0
    s_nop 0
    buffer_load_dwordx4 v7, s[28:31], s45 offen lds
    s_add_u32 s45, s45, 131072
    s_add_u32 m0, s44, 1024
    s_nop 0
    buffer_load_dwordx4 v7, s[28:31], s45 offen lds
    s_add_u32 s45, s45, 131072
    s_add_u32 m0, s44, 2048
    s_nop 0
    buffer_load_dwordx4 v7, s[28:31], s45 offen lds
    s_add_u32 s45, s45, 131072
    v_mfma_f32_16x16x32_bf16 v[12:15], v[112:115], v[240:243], v[12:15]
    ds_read_b128 v[32:35], v3 offset:20480
    v_mfma_f32_16x16x32_bf16 v[16:19], v[116:119], v[240:243], v[16:19]
    ds_read_b128 v[36:39], v3 offset:21504
    v_mfma_f32_16x16x32_bf16 v[20:23], v[120:123], v[240:243], v[20:23]
    ds_read_b128 v[40:43], v3 offset:22528
    v_mfma_f32_16x16x32_bf16 v[24:27], v[124:127], v[240:243], v[24:27]
    ds_read_b128 v[44:47], v3 offset:23552
    v_mfma_f32_16x16x32_bf16 v[28:31], v[128:131], v[240:243], v[28:31]
    ds_read_b128 v[48:51], v3 offset:24576
    v_mfma_f32_16x16x32_bf16 v[12:15], v[132:135], v[244:247], v[12:15]
    ds_read_b128 v[52:55], v3 offset:25600
    v_mfma_f32_16x16x32_bf16 v[16:19], v[136:139], v[244:247], v[16:19]
    ds_read_b128 v[56:59], v3 offset:26624
    v_mfma_f32_16x16x32_bf16 v[20:23], v[140:143], v[244:247], v[20:23]
    ds_read_b128 v[60:63], v3 offset:27648
    v_mfma_f32_16x16x32_bf16 v[24:27], v[144:147], v[244:247], v[24:27]
    ds_read_b128 v[64:67], v3 offset:28672
    v_mfma_f32_16x16x32_bf16 v[28:31], v[148:151], v[244:247], v[28:31]
    ds_read_b128 v[68:71], v3 offset:29696
    v_mfma_f32_16x16x32_bf16 v[12:15], v[152:155], v[248:251], v[12:15]
    ds_read_b128 v[72:75], v3 offset:30720
    v_mfma_f32_16x16x32_bf16 v[16:19], v[156:159], v[248:251], v[16:19]
    ds_read_b128 v[76:79], v3 offset:31744
    v_mfma_f32_16x16x32_bf16 v[20:23], v[160:163], v[248:251], v[20:23]
    ds_read_b128 v[80:83], v3 offset:32768
    v_mfma_f32_16x16x32_bf16 v[24:27], v[164:167], v[248:251], v[24:27]
    ds_read_b128 v[84:87], v3 offset:33792
    v_mfma_f32_16x16x32_bf16 v[28:31], v[168:171], v[248:251], v[28:31]
    ds_read_b128 v[88:91], v3 offset:34816
    v_mfma_f32_16x16x32_bf16 v[12:15], v[172:175], v[252:255], v[12:15]
    ds_read_b128 v[92:95], v3 offset:35840
    v_mfma_f32_16x16x32_bf16 v[16:19], v[176:179], v[252:255], v[16:19]
    ds_read_b128 v[96:99], v3 offset:36864
    v_mfma_f32_16x16x32_bf16 v[20:23], v[180:183], v[252:255], v[20:23]
    ds_read_b128 v[100:103], v3 offset:37888
    v_mfma_f32_16x16x32_bf16 v[24:27], v[184:187], v[252:255], v[24:27]
    ds_read_b128 v[104:107], v3 offset:38912
    v_mfma_f32_16x16x32_bf16 v[28:31], v[188:191], v[252:255], v[28:31]
    ds_read_b128 v[108:111], v3 offset:39936
    s_waitcnt lgkmcnt(0)
    s_barrier
    s_waitcnt vmcnt(11)
    buffer_load_dwordx4 v[240:243], v3, s[28:31], s24 offen offset:0
    buffer_load_dwordx4 v[244:247], v3, s[28:31], s24 offen offset:1024
    buffer_load_dwordx4 v[248:251], v3, s[28:31], s24 offen offset:2048
    buffer_load_dwordx4 v[252:255], v3, s[28:31], s24 offen offset:3072
    s_add_u32 s24, s24, 4096
    v_mfma_f32_16x16x32_bf16 v[12:15], v[32:35], v[192:195], v[12:15]
    ds_read_b128 v[112:115], v3 offset:40960
    v_mfma_f32_16x16x32_bf16 v[16:19], v[36:39], v[192:195], v[16:19]
    ds_read_b128 v[116:119], v3 offset:41984
    v_mfma_f32_16x16x32_bf16 v[20:23], v[40:43], v[192:195], v[20:23]
    ds_read_b128 v[120:123], v3 offset:43008
    v_mfma_f32_16x16x32_bf16 v[24:27], v[44:47], v[192:195], v[24:27]
    ds_read_b128 v[124:127], v3 offset:44032
    v_mfma_f32_16x16x32_bf16 v[28:31], v[48:51], v[192:195], v[28:31]
    ds_read_b128 v[128:131], v3 offset:45056
    v_mfma_f32_16x16x32_bf16 v[12:15], v[52:55], v[196:199], v[12:15]
    ds_read_b128 v[132:135], v3 offset:46080
    v_mfma_f32_16x16x32_bf16 v[16:19], v[56:59], v[196:199], v[16:19]
    ds_read_b128 v[136:139], v3 offset:47104
    v_mfma_f32_16x16x32_bf16 v[20:23], v[60:63], v[196:199], v[20:23]
    ds_read_b128 v[140:143], v3 offset:48128
    v_mfma_f32_16x16x32_bf16 v[24:27], v[64:67], v[196:199], v[24:27]
    ds_read_b128 v[144:147], v3 offset:49152
    v_mfma_f32_16x16x32_bf16 v[28:31], v[68:71], v[196:199], v[28:31]
    ds_read_b128 v[148:151], v3 offset:50176
    v_mfma_f32_16x16x32_bf16 v[12:15], v[72:75], v[200:203], v[12:15]
    ds_read_b128 v[152:155], v3 offset:51200
    v_mfma_f32_16x16x32_bf16 v[16:19], v[76:79], v[200:203], v[16:19]
    ds_read_b128 v[156:159], v3 offset:52224
    v_mfma_f32_16x16x32_bf16 v[20:23], v[80:83], v[200:203], v[20:23]
    ds_read_b128 v[160:163], v3 offset:53248
    v_mfma_f32_16x16x32_bf16 v[24:27], v[84:87], v[200:203], v[24:27]
    ds_read_b128 v[164:167], v3 offset:54272
    v_mfma_f32_16x16x32_bf16 v[28:31], v[88:91], v[200:203], v[28:31]
    ds_read_b128 v[168:171], v3 offset:55296
    v_mfma_f32_16x16x32_bf16 v[12:15], v[92:95], v[204:207], v[12:15]
    ds_read_b128 v[172:175], v3 offset:56320
    v_mfma_f32_16x16x32_bf16 v[16:19], v[96:99], v[204:207], v[16:19]
    ds_read_b128 v[176:179], v3 offset:57344
    v_mfma_f32_16x16x32_bf16 v[20:23], v[100:103], v[204:207], v[20:23]
    ds_read_b128 v[180:183], v3 offset:58368
    v_mfma_f32_16x16x32_bf16 v[24:27], v[104:107], v[204:207], v[24:27]
    ds_read_b128 v[184:187], v3 offset:59392
    v_mfma_f32_16x16x32_bf16 v[28:31], v[108:111], v[204:207], v[28:31]
    ds_read_b128 v[188:191], v3 offset:60416
    s_waitcnt lgkmcnt(0)
    s_barrier
    s_waitcnt vmcnt(11)
    v_mfma_f32_16x16x32_bf16 v[12:15], v[112:115], v[208:211], v[12:15]
    ds_read_b128 v[32:35], v4 offset:0
    v_mfma_f32_16x16x32_bf16 v[16:19], v[116:119], v[208:211], v[16:19]
    ds_read_b128 v[36:39], v4 offset:1024
    v_mfma_f32_16x16x32_bf16 v[20:23], v[120:123], v[208:211], v[20:23]
    ds_read_b128 v[40:43], v4 offset:2048
    v_mfma_f32_16x16x32_bf16 v[24:27], v[124:127], v[208:211], v[24:27]
    ds_read_b128 v[44:47], v4 offset:3072
    v_mfma_f32_16x16x32_bf16 v[28:31], v[128:131], v[208:211], v[28:31]
    ds_read_b128 v[48:51], v4 offset:4096
    v_mfma_f32_16x16x32_bf16 v[12:15], v[132:135], v[212:215], v[12:15]
    ds_read_b128 v[52:55], v4 offset:5120
    v_mfma_f32_16x16x32_bf16 v[16:19], v[136:139], v[212:215], v[16:19]
    ds_read_b128 v[56:59], v4 offset:6144
    v_mfma_f32_16x16x32_bf16 v[20:23], v[140:143], v[212:215], v[20:23]
    ds_read_b128 v[60:63], v4 offset:7168
    v_mfma_f32_16x16x32_bf16 v[24:27], v[144:147], v[212:215], v[24:27]
    ds_read_b128 v[64:67], v4 offset:8192
    v_mfma_f32_16x16x32_bf16 v[28:31], v[148:151], v[212:215], v[28:31]
    ds_read_b128 v[68:71], v4 offset:9216
    v_mfma_f32_16x16x32_bf16 v[12:15], v[152:155], v[216:219], v[12:15]
    ds_read_b128 v[72:75], v4 offset:10240
    v_mfma_f32_16x16x32_bf16 v[16:19], v[156:159], v[216:219], v[16:19]
    ds_read_b128 v[76:79], v4 offset:11264
    v_mfma_f32_16x16x32_bf16 v[20:23], v[160:163], v[216:219], v[20:23]
    ds_read_b128 v[80:83], v4 offset:12288
    v_mfma_f32_16x16x32_bf16 v[24:27], v[164:167], v[216:219], v[24:27]
    ds_read_b128 v[84:87], v4 offset:13312
    v_mfma_f32_16x16x32_bf16 v[28:31], v[168:171], v[216:219], v[28:31]
    ds_read_b128 v[88:91], v4 offset:14336
    v_mfma_f32_16x16x32_bf16 v[12:15], v[172:175], v[220:223], v[12:15]
    ds_read_b128 v[92:95], v4 offset:15360
    v_mfma_f32_16x16x32_bf16 v[16:19], v[176:179], v[220:223], v[16:19]
    ds_read_b128 v[96:99], v4 offset:16384
    v_mfma_f32_16x16x32_bf16 v[20:23], v[180:183], v[220:223], v[20:23]
    ds_read_b128 v[100:103], v4 offset:17408
    v_mfma_f32_16x16x32_bf16 v[24:27], v[184:187], v[220:223], v[24:27]
    ds_read_b128 v[104:107], v4 offset:18432
    v_mfma_f32_16x16x32_bf16 v[28:31], v[188:191], v[220:223], v[28:31]
    ds_read_b128 v[108:111], v4 offset:19456
    s_waitcnt lgkmcnt(0)
    s_barrier
    s_waitcnt vmcnt(7)
    v_mfma_f32_16x16x32_bf16 v[12:15], v[32:35], v[224:227], v[12:15]
    ds_read_b128 v[112:115], v4 offset:20480
    v_mfma_f32_16x16x32_bf16 v[16:19], v[36:39], v[224:227], v[16:19]
    ds_read_b128 v[116:119], v4 offset:21504
    v_mfma_f32_16x16x32_bf16 v[20:23], v[40:43], v[224:227], v[20:23]
    ds_read_b128 v[120:123], v4 offset:22528
    v_mfma_f32_16x16x32_bf16 v[24:27], v[44:47], v[224:227], v[24:27]
    ds_read_b128 v[124:127], v4 offset:23552
    v_mfma_f32_16x16x32_bf16 v[28:31], v[48:51], v[224:227], v[28:31]
    ds_read_b128 v[128:131], v4 offset:24576
    v_mfma_f32_16x16x32_bf16 v[12:15], v[52:55], v[228:231], v[12:15]
    ds_read_b128 v[132:135], v4 offset:25600
    v_mfma_f32_16x16x32_bf16 v[16:19], v[56:59], v[228:231], v[16:19]
    ds_read_b128 v[136:139], v4 offset:26624
    v_mfma_f32_16x16x32_bf16 v[20:23], v[60:63], v[228:231], v[20:23]
    ds_read_b128 v[140:143], v4 offset:27648
    v_mfma_f32_16x16x32_bf16 v[24:27], v[64:67], v[228:231], v[24:27]
    ds_read_b128 v[144:147], v4 offset:28672
    v_mfma_f32_16x16x32_bf16 v[28:31], v[68:71], v[228:231], v[28:31]
    ds_read_b128 v[148:151], v4 offset:29696
    v_mfma_f32_16x16x32_bf16 v[12:15], v[72:75], v[232:235], v[12:15]
    ds_read_b128 v[152:155], v4 offset:30720
    v_mfma_f32_16x16x32_bf16 v[16:19], v[76:79], v[232:235], v[16:19]
    ds_read_b128 v[156:159], v4 offset:31744
    v_mfma_f32_16x16x32_bf16 v[20:23], v[80:83], v[232:235], v[20:23]
    ds_read_b128 v[160:163], v4 offset:32768
    v_mfma_f32_16x16x32_bf16 v[24:27], v[84:87], v[232:235], v[24:27]
    ds_read_b128 v[164:167], v4 offset:33792
    v_mfma_f32_16x16x32_bf16 v[28:31], v[88:91], v[232:235], v[28:31]
    ds_read_b128 v[168:171], v4 offset:34816
    v_mfma_f32_16x16x32_bf16 v[12:15], v[92:95], v[236:239], v[12:15]
    ds_read_b128 v[172:175], v4 offset:35840
    v_mfma_f32_16x16x32_bf16 v[16:19], v[96:99], v[236:239], v[16:19]
    ds_read_b128 v[176:179], v4 offset:36864
    v_mfma_f32_16x16x32_bf16 v[20:23], v[100:103], v[236:239], v[20:23]
    ds_read_b128 v[180:183], v4 offset:37888
    v_mfma_f32_16x16x32_bf16 v[24:27], v[104:107], v[236:239], v[24:27]
    ds_read_b128 v[184:187], v4 offset:38912
    v_mfma_f32_16x16x32_bf16 v[28:31], v[108:111], v[236:239], v[28:31]
    ds_read_b128 v[188:191], v4 offset:39936
    s_waitcnt lgkmcnt(0)
    s_waitcnt vmcnt(0)
    v_mfma_f32_16x16x32_bf16 v[12:15], v[112:115], v[240:243], v[12:15]
    ds_read_b64_tr_b16 v[32:33], v8 offset:0
    v_mfma_f32_16x16x32_bf16 v[16:19], v[116:119], v[240:243], v[16:19]
    ds_read_b64_tr_b16 v[34:35], v8 offset:512
    v_mfma_f32_16x16x32_bf16 v[20:23], v[120:123], v[240:243], v[20:23]
    ds_read_b64_tr_b16 v[36:37], v8 offset:1024
    v_mfma_f32_16x16x32_bf16 v[24:27], v[124:127], v[240:243], v[24:27]
    ds_read_b64_tr_b16 v[38:39], v8 offset:1536
    v_mfma_f32_16x16x32_bf16 v[28:31], v[128:131], v[240:243], v[28:31]
    ds_read_b64_tr_b16 v[40:41], v8 offset:2048
    v_mfma_f32_16x16x32_bf16 v[12:15], v[132:135], v[244:247], v[12:15]
    v_mfma_f32_16x16x32_bf16 v[16:19], v[136:139], v[244:247], v[16:19]
    v_mfma_f32_16x16x32_bf16 v[20:23], v[140:143], v[244:247], v[20:23]
    v_mfma_f32_16x16x32_bf16 v[24:27], v[144:147], v[244:247], v[24:27]
    v_mfma_f32_16x16x32_bf16 v[28:31], v[148:151], v[244:247], v[28:31]
    v_mfma_f32_16x16x32_bf16 v[12:15], v[152:155], v[248:251], v[12:15]
    v_mfma_f32_16x16x32_bf16 v[16:19], v[156:159], v[248:251], v[16:19]
    v_mfma_f32_16x16x32_bf16 v[20:23], v[160:163], v[248:251], v[20:23]
    v_mfma_f32_16x16x32_bf16 v[24:27], v[164:167], v[248:251], v[24:27]
    v_mfma_f32_16x16x32_bf16 v[28:31], v[168:171], v[248:251], v[28:31]
    v_mfma_f32_16x16x32_bf16 v[12:15], v[172:175], v[252:255], v[12:15]
    v_mfma_f32_16x16x32_bf16 v[16:19], v[176:179], v[252:255], v[16:19]
    v_mfma_f32_16x16x32_bf16 v[20:23], v[180:183], v[252:255], v[20:23]
    v_mfma_f32_16x16x32_bf16 v[24:27], v[184:187], v[252:255], v[24:27]
    v_mfma_f32_16x16x32_bf16 v[28:31], v[188:191], v[252:255], v[28:31]
    s_waitcnt lgkmcnt(0)
    v_lshlrev_b32 v48, 16, v32
    v_and_b32 v49, 0xffff0000, v32
    v_lshlrev_b32 v50, 16, v33
    v_and_b32 v51, 0xffff0000, v33
    v_lshlrev_b32 v52, 16, v34
    v_and_b32 v53, 0xffff0000, v34
    v_lshlrev_b32 v54, 16, v35
    v_and_b32 v55, 0xffff0000, v35
    v_lshlrev_b32 v56, 16, v36
    v_and_b32 v57, 0xffff0000, v36
    v_lshlrev_b32 v58, 16, v37
    v_and_b32 v59, 0xffff0000, v37
    v_lshlrev_b32 v60, 16, v38
    v_and_b32 v61, 0xffff0000, v38
    v_lshlrev_b32 v62, 16, v39
    v_and_b32 v63, 0xffff0000, v39
    v_lshlrev_b32 v64, 16, v40
    v_and_b32 v65, 0xffff0000, v40
    v_lshlrev_b32 v66, 16, v41
    v_and_b32 v67, 0xffff0000, v41
    v_cvt_pk_bf16_f32 v72, v12, v13
    v_cvt_pk_bf16_f32 v74, v14, v15
    v_lshlrev_b32 v12, 16, v72
    v_and_b32 v13, 0xffff0000, v72
    v_lshlrev_b32 v14, 16, v74
    v_and_b32 v15, 0xffff0000, v74
    v_pk_add_f32 v[12:13], v[12:13], v[48:49]
    v_pk_add_f32 v[14:15], v[14:15], v[50:51]
    v_cvt_pk_bf16_f32 v72, v12, v13
    v_cvt_pk_bf16_f32 v73, v14, v15
    buffer_store_dwordx2 v[72:73], v6, s[40:43], s25 offen offset:0
    v_cvt_pk_bf16_f32 v76, v16, v17
    v_cvt_pk_bf16_f32 v78, v18, v19
    v_lshlrev_b32 v16, 16, v76
    v_and_b32 v17, 0xffff0000, v76
    v_lshlrev_b32 v18, 16, v78
    v_and_b32 v19, 0xffff0000, v78
    v_pk_add_f32 v[16:17], v[16:17], v[52:53]
    v_pk_add_f32 v[18:19], v[18:19], v[54:55]
    v_cvt_pk_bf16_f32 v76, v16, v17
    v_cvt_pk_bf16_f32 v77, v18, v19
    buffer_store_dwordx2 v[76:77], v6, s[40:43], s25 offen offset:32
    v_cvt_pk_bf16_f32 v80, v20, v21
    v_cvt_pk_bf16_f32 v82, v22, v23
    v_lshlrev_b32 v20, 16, v80
    v_and_b32 v21, 0xffff0000, v80
    v_lshlrev_b32 v22, 16, v82
    v_and_b32 v23, 0xffff0000, v82
    v_pk_add_f32 v[20:21], v[20:21], v[56:57]
    v_pk_add_f32 v[22:23], v[22:23], v[58:59]
    v_cvt_pk_bf16_f32 v80, v20, v21
    v_cvt_pk_bf16_f32 v81, v22, v23
    buffer_store_dwordx2 v[80:81], v6, s[40:43], s25 offen offset:64
    v_cvt_pk_bf16_f32 v84, v24, v25
    v_cvt_pk_bf16_f32 v86, v26, v27
    v_lshlrev_b32 v24, 16, v84
    v_and_b32 v25, 0xffff0000, v84
    v_lshlrev_b32 v26, 16, v86
    v_and_b32 v27, 0xffff0000, v86
    v_pk_add_f32 v[24:25], v[24:25], v[60:61]
    v_pk_add_f32 v[26:27], v[26:27], v[62:63]
    v_cvt_pk_bf16_f32 v84, v24, v25
    v_cvt_pk_bf16_f32 v85, v26, v27
    buffer_store_dwordx2 v[84:85], v6, s[40:43], s25 offen offset:96
    v_cvt_pk_bf16_f32 v88, v28, v29
    v_cvt_pk_bf16_f32 v90, v30, v31
    v_lshlrev_b32 v28, 16, v88
    v_and_b32 v29, 0xffff0000, v88
    v_lshlrev_b32 v30, 16, v90
    v_and_b32 v31, 0xffff0000, v90
    v_pk_add_f32 v[28:29], v[28:29], v[64:65]
    v_pk_add_f32 v[30:31], v[30:31], v[66:67]
    v_cvt_pk_bf16_f32 v88, v28, v29
    v_cvt_pk_bf16_f32 v89, v30, v31
    buffer_store_dwordx2 v[88:89], v6, s[40:43], s25 offen offset:128
    s_endpgm
L_k3_ld:
    s_sub_u32 s18, s18, 4
    s_mul_i32 s26, s18, 5120
    s_mul_i32 s24, s17, 245760
    s_add_u32 s24, s24, s26
    s_add_u32 s24, s24, 16777216
    s_waitcnt lgkmcnt(0)
    s_mov_b32 s28, s12
    s_mov_b32 s29, s13
    s_mov_b32 s30, 18874368
    s_mov_b32 s31, 0x00020000
    s_add_u32 m0, s26, 0
    s_add_u32 s25, s24, 0
    buffer_load_dwordx4 v3, s[28:31], s25 offen lds
    s_add_u32 m0, s26, 1024
    s_add_u32 s25, s24, 1024
    buffer_load_dwordx4 v3, s[28:31], s25 offen lds
    s_add_u32 m0, s26, 2048
    s_add_u32 s25, s24, 2048
    buffer_load_dwordx4 v3, s[28:31], s25 offen lds
    s_add_u32 m0, s26, 3072
    s_add_u32 s25, s24, 3072
    buffer_load_dwordx4 v3, s[28:31], s25 offen lds
    s_add_u32 m0, s26, 4096
    s_add_u32 s25, s24, 4096
    buffer_load_dwordx4 v3, s[28:31], s25 offen lds
    s_add_u32 m0, s26, 20480
    s_add_u32 s25, s24, 20480
    buffer_load_dwordx4 v3, s[28:31], s25 offen lds
    s_add_u32 m0, s26, 21504
    s_add_u32 s25, s24, 21504
    buffer_load_dwordx4 v3, s[28:31], s25 offen lds
    s_add_u32 m0, s26, 22528
    s_add_u32 s25, s24, 22528
    buffer_load_dwordx4 v3, s[28:31], s25 offen lds
    s_add_u32 m0, s26, 23552
    s_add_u32 s25, s24, 23552
    buffer_load_dwordx4 v3, s[28:31], s25 offen lds
    s_add_u32 m0, s26, 24576
    s_add_u32 s25, s24, 24576
    buffer_load_dwordx4 v3, s[28:31], s25 offen lds
    s_waitcnt vmcnt(5)
    s_barrier
    s_add_u32 m0, s26, 40960
    s_add_u32 s25, s24, 40960
    buffer_load_dwordx4 v3, s[28:31], s25 offen lds
    s_add_u32 m0, s26, 41984
    s_add_u32 s25, s24, 41984
    buffer_load_dwordx4 v3, s[28:31], s25 offen lds
    s_add_u32 m0, s26, 43008
    s_add_u32 s25, s24, 43008
    buffer_load_dwordx4 v3, s[28:31], s25 offen lds
    s_add_u32 m0, s26, 44032
    s_add_u32 s25, s24, 44032
    buffer_load_dwordx4 v3, s[28:31], s25 offen lds
    s_add_u32 m0, s26, 45056
    s_add_u32 s25, s24, 45056
    buffer_load_dwordx4 v3, s[28:31], s25 offen lds
    s_add_u32 m0, s26, 61440
    s_add_u32 s25, s24, 61440
    buffer_load_dwordx4 v3, s[28:31], s25 offen lds
    s_add_u32 m0, s26, 62464
    s_add_u32 s25, s24, 62464
    buffer_load_dwordx4 v3, s[28:31], s25 offen lds
    s_waitcnt vmcnt(7)
    s_barrier
    s_add_u32 m0, s26, 63488
    s_add_u32 s25, s24, 63488
    buffer_load_dwordx4 v3, s[28:31], s25 offen lds
    s_add_u32 m0, s26, 64512
    s_add_u32 s25, s24, 64512
    buffer_load_dwordx4 v3, s[28:31], s25 offen lds
    s_add_u32 m0, s26, 65536
    s_add_u32 s25, s24, 65536
    buffer_load_dwordx4 v3, s[28:31], s25 offen lds
    s_add_u32 m0, s26, 81920
    s_add_u32 s25, s24, 81920
    buffer_load_dwordx4 v3, s[28:31], s25 offen lds
    s_add_u32 m0, s26, 82944
    s_add_u32 s25, s24, 82944
    buffer_load_dwordx4 v3, s[28:31], s25 offen lds
    s_add_u32 m0, s26, 83968
    s_add_u32 s25, s24, 83968
    buffer_load_dwordx4 v3, s[28:31], s25 offen lds
    s_add_u32 m0, s26, 84992
    s_add_u32 s25, s24, 84992
    buffer_load_dwordx4 v3, s[28:31], s25 offen lds
    s_waitcnt vmcnt(9)
    s_barrier
    s_add_u32 m0, s26, 86016
    s_add_u32 s25, s24, 86016
    buffer_load_dwordx4 v3, s[28:31], s25 offen lds
    s_add_u32 m0, s26, 102400
    s_add_u32 s25, s24, 102400
    buffer_load_dwordx4 v3, s[28:31], s25 offen lds
    s_add_u32 m0, s26, 103424
    s_add_u32 s25, s24, 103424
    buffer_load_dwordx4 v3, s[28:31], s25 offen lds
    s_add_u32 m0, s26, 104448
    s_add_u32 s25, s24, 104448
    buffer_load_dwordx4 v3, s[28:31], s25 offen lds
    s_add_u32 m0, s26, 105472
    s_add_u32 s25, s24, 105472
    buffer_load_dwordx4 v3, s[28:31], s25 offen lds
    s_add_u32 m0, s26, 106496
    s_add_u32 s25, s24, 106496
    buffer_load_dwordx4 v3, s[28:31], s25 offen lds
    s_add_u32 m0, s26, 122880
    s_add_u32 s25, s24, 122880
    buffer_load_dwordx4 v3, s[28:31], s25 offen lds
    s_waitcnt vmcnt(11)
    s_barrier
    s_add_u32 m0, s26, 123904
    s_add_u32 s25, s24, 123904
    buffer_load_dwordx4 v3, s[28:31], s25 offen lds
    s_add_u32 m0, s26, 124928
    s_add_u32 s25, s24, 124928
    buffer_load_dwordx4 v3, s[28:31], s25 offen lds
    s_add_u32 m0, s26, 125952
    s_add_u32 s25, s24, 125952
    buffer_load_dwordx4 v3, s[28:31], s25 offen lds
    s_add_u32 m0, s26, 126976
    s_add_u32 s25, s24, 126976
    buffer_load_dwordx4 v3, s[28:31], s25 offen lds
    s_add_u32 m0, s26, 0
    s_add_u32 s25, s24, 143360
    buffer_load_dwordx4 v3, s[28:31], s25 offen lds
    s_add_u32 m0, s26, 1024
    s_add_u32 s25, s24, 144384
    buffer_load_dwordx4 v3, s[28:31], s25 offen lds
    s_add_u32 m0, s26, 2048
    s_add_u32 s25, s24, 145408
    buffer_load_dwordx4 v3, s[28:31], s25 offen lds
    s_waitcnt vmcnt(13)
    s_barrier
    s_add_u32 m0, s26, 3072
    s_add_u32 s25, s24, 146432
    buffer_load_dwordx4 v3, s[28:31], s25 offen lds
    s_add_u32 m0, s26, 4096
    s_add_u32 s25, s24, 147456
    buffer_load_dwordx4 v3, s[28:31], s25 offen lds
    s_add_u32 m0, s26, 20480
    s_add_u32 s25, s24, 163840
    buffer_load_dwordx4 v3, s[28:31], s25 offen lds
    s_add_u32 m0, s26, 21504
    s_add_u32 s25, s24, 164864
    buffer_load_dwordx4 v3, s[28:31], s25 offen lds
    s_add_u32 m0, s26, 22528
    s_add_u32 s25, s24, 165888
    buffer_load_dwordx4 v3, s[28:31], s25 offen lds
    s_add_u32 m0, s26, 23552
    s_add_u32 s25, s24, 166912
    buffer_load_dwordx4 v3, s[28:31], s25 offen lds
    s_add_u32 m0, s26, 24576
    s_add_u32 s25, s24, 167936
    buffer_load_dwordx4 v3, s[28:31], s25 offen lds
    s_waitcnt vmcnt(15)
    s_barrier
    s_add_u32 m0, s26, 40960
    s_add_u32 s25, s24, 184320
    buffer_load_dwordx4 v3, s[28:31], s25 offen lds
    s_add_u32 m0, s26, 41984
    s_add_u32 s25, s24, 185344
    buffer_load_dwordx4 v3, s[28:31], s25 offen lds
    s_add_u32 m0, s26, 43008
    s_add_u32 s25, s24, 186368
    buffer_load_dwordx4 v3, s[28:31], s25 offen lds
    s_add_u32 m0, s26, 44032
    s_add_u32 s25, s24, 187392
    buffer_load_dwordx4 v3, s[28:31], s25 offen lds
    s_add_u32 m0, s26, 45056
    s_add_u32 s25, s24, 188416
    buffer_load_dwordx4 v3, s[28:31], s25 offen lds
    s_add_u32 m0, s26, 61440
    s_add_u32 s25, s24, 204800
    buffer_load_dwordx4 v3, s[28:31], s25 offen lds
    s_add_u32 m0, s26, 62464
    s_add_u32 s25, s24, 205824
    buffer_load_dwordx4 v3, s[28:31], s25 offen lds
    s_waitcnt vmcnt(17)
    s_barrier
    s_add_u32 m0, s26, 63488
    s_add_u32 s25, s24, 206848
    buffer_load_dwordx4 v3, s[28:31], s25 offen lds
    s_add_u32 m0, s26, 64512
    s_add_u32 s25, s24, 207872
    buffer_load_dwordx4 v3, s[28:31], s25 offen lds
    s_add_u32 m0, s26, 65536
    s_add_u32 s25, s24, 208896
    buffer_load_dwordx4 v3, s[28:31], s25 offen lds
    s_add_u32 m0, s26, 81920
    s_add_u32 s25, s24, 225280
    buffer_load_dwordx4 v3, s[28:31], s25 offen lds
    s_add_u32 m0, s26, 82944
    s_add_u32 s25, s24, 226304
    buffer_load_dwordx4 v3, s[28:31], s25 offen lds
    s_add_u32 m0, s26, 83968
    s_add_u32 s25, s24, 227328
    buffer_load_dwordx4 v3, s[28:31], s25 offen lds
    s_add_u32 m0, s26, 84992
    s_add_u32 s25, s24, 228352
    buffer_load_dwordx4 v3, s[28:31], s25 offen lds
    s_waitcnt vmcnt(19)
    s_barrier
    s_add_u32 m0, s26, 86016
    s_add_u32 s25, s24, 229376
    buffer_load_dwordx4 v3, s[28:31], s25 offen lds
    s_waitcnt vmcnt(15)
    s_barrier
    s_waitcnt vmcnt(10)
    s_barrier
    s_waitcnt vmcnt(5)
    s_barrier
    s_waitcnt vmcnt(0)
    s_barrier
L_k3_end:
    s_endpgm
.section .rodata,"a"
.p2align 6
.amdhsa_kernel k0_kernel
  .amdhsa_next_free_vgpr 144
  .amdhsa_next_free_sgpr 64
  .amdhsa_accum_offset 144
  .amdhsa_group_segment_fixed_size 0
  .amdhsa_kernarg_size 104
  .amdhsa_user_sgpr_count 2
  .amdhsa_user_sgpr_kernarg_segment_ptr 1
  .amdhsa_system_sgpr_workgroup_id_x 1
.end_amdhsa_kernel
.p2align 6
.amdhsa_kernel k1_kernel
  .amdhsa_next_free_vgpr 168
  .amdhsa_next_free_sgpr 64
  .amdhsa_accum_offset 168
  .amdhsa_group_segment_fixed_size 0
  .amdhsa_kernarg_size 104
  .amdhsa_user_sgpr_count 2
  .amdhsa_user_sgpr_kernarg_segment_ptr 1
  .amdhsa_system_sgpr_workgroup_id_x 1
.end_amdhsa_kernel
.p2align 6
.amdhsa_kernel k2_kernel
  .amdhsa_next_free_vgpr 252
  .amdhsa_next_free_sgpr 64
  .amdhsa_accum_offset 252
  .amdhsa_group_segment_fixed_size 0
  .amdhsa_kernarg_size 104
  .amdhsa_user_sgpr_count 2
  .amdhsa_user_sgpr_kernarg_segment_ptr 1
  .amdhsa_system_sgpr_workgroup_id_x 1
.end_amdhsa_kernel
.p2align 6
.amdhsa_kernel k3_kernel
  .amdhsa_next_free_vgpr 256
  .amdhsa_next_free_sgpr 64
  .amdhsa_accum_offset 256
  .amdhsa_group_segment_fixed_size 0
  .amdhsa_kernarg_size 104
  .amdhsa_user_sgpr_count 2
  .amdhsa_user_sgpr_kernarg_segment_ptr 1
  .amdhsa_system_sgpr_workgroup_id_x 1
.end_amdhsa_kernel
```
